```python
import torch

def _softmax(x, axis=-1):
    return torch.softmax(x, dim=axis)
def _gelu(x):
    return torch.nn.functional.gelu(x, approximate="tanh")
def _silu(x):
    return torch.nn.functional.silu(x)
def _sigmoid(x):
    return torch.sigmoid(x)
def _layernorm(x, axis=-1, eps=1e-5):
    m = x.mean(dim=axis, keepdim=True)
    v = x.var(dim=axis, keepdim=True, unbiased=False)
    return (x - m) / torch.sqrt(v + eps)
def _scatter_add(tgt, idx, src, axis=0):
    return tgt.clone().index_add_(axis, idx, src)
def _segment_sum(src, seg, n):
    out = torch.zeros((n,) + src.shape[1:], dtype=src.dtype)
    return out.index_add_(0, seg, src)
def _pad(x, pw):
    flat = tuple(v for pair in reversed(pw) for v in pair)
    return torch.nn.functional.pad(x, flat)

kernel_name = 'concat_heads__mha_block__linear_kernel_hedgehog__prompt'

def setup_inputs():

    _w = (lambda a: (lambda t: t.to(torch.bfloat16) if t.is_floating_point() else t)(torch.as_tensor(a)))
    def _A_setup():
        B, S, D, H = 1, 2048, 640, 32
        return {
            "x": _w((lambda *s: torch.randn(*s, dtype=torch.bfloat16) * 0.2)(B, S, D)),
            "wqkv": _w((lambda *s: torch.randn(*s, dtype=torch.bfloat16) * 0.2)(D, 3 * D)),
            "wo": _w((lambda *s: torch.randn(*s, dtype=torch.bfloat16) * 0.05)(D, D)),
        }
    _A_in = _A_setup()

    def _B_setup():
        B, S, D, H = 1, 2048, 640, 32
        Dh = D // H
        return {
            "x": _w((lambda *s: torch.randn(*s, dtype=torch.bfloat16) * 0.4)(B, S, D)),
            "wqkv": _w((lambda *s: torch.randn(*s, dtype=torch.bfloat16) * 0.4)(D, 3 * D)),
            "w_phi": _w((lambda *s: torch.randn(*s, dtype=torch.bfloat16) * 0.4)(H, Dh, Dh) * (Dh ** -0.5)),
            "wo": _w((lambda *s: torch.randn(*s, dtype=torch.bfloat16) * 0.05)(D, D)),
        }
    _B_in = _B_setup()

    return {
        "A_x": _A_in["x"],
        "A_wqkv": _A_in["wqkv"],
        "A_wo": _A_in["wo"],
        "B_x": _B_in["x"],
        "B_wqkv": _B_in["wqkv"],
        "B_w_phi": _B_in["w_phi"],
        "B_wo": _B_in["wo"],
    }

def reference(A_x, A_wqkv, A_wo, B_x, B_wqkv, B_w_phi, B_wo):
    def _A_ref(x, wqkv, wo):
        B, S, D = x.shape
        H = 32
        Dh = D // H
        qkv = (lambda x, *d: x.permute(*d))((x @ wqkv).reshape(B, S, 3, H, Dh), 2, 0, 3, 1, 4)
        q, k, v = qkv[0], qkv[1], qkv[2]
        scores = torch.einsum("bhqd,bhkd->bhqk", q, k) * (Dh ** -0.5)
        p = _softmax(scores, axis=-1)
        o = torch.einsum("bhqk,bhkd->bhqd", p, v)
        return (lambda x, *d: x.permute(*d))(o, 0, 2, 1, 3).reshape(B, S, D) @ wo

    def _B_ref(x, wqkv, w_phi, wo):
        B, S, D = x.shape
        H = 32; Dh = D // H
        qkv = (lambda x, *d: x.permute(*d))((x @ wqkv).reshape(B, S, 3, H, Dh), 2, 0, 3, 1, 4)
        q, k, v = qkv[0], qkv[1], qkv[2]
        pq = torch.einsum("bhsd,hdf->bhsf", q, w_phi)
        pk = torch.einsum("bhsd,hdf->bhsf", k, w_phi)
        phi_q = torch.concatenate([_softmax(pq, axis=-1), _softmax(-pq, axis=-1)], axis=-1)
        phi_k = torch.concatenate([_softmax(pk, axis=-1), _softmax(-pk, axis=-1)], axis=-1)
        kv = torch.einsum("bhsf,bhsd->bhfd", phi_k, v)
        z  = torch.einsum("bhsf->bhf", phi_k)
        num = torch.einsum("bhqf,bhfd->bhqd", phi_q, kv)
        den = torch.einsum("bhqf,bhf->bhq", phi_q, z)[..., None] + 1e-6
        o = num / den
        return (lambda x, *d: x.permute(*d))(o, 0, 2, 1, 3).reshape(B, S, D) @ wo

    a = _A_ref(A_x, A_wqkv, A_wo)
    b = _B_ref(B_x, B_wqkv, B_w_phi, B_wo)
    return torch.concatenate([a, b], axis=-1)
```

```asm
; @launch grid=(256,1,1) block=(512,1,1) lds=163840
.amdgcn_target "amdgcn-amd-amdhsa--gfx950"
.text
.globl concat_heads__mha_block__linear_kernel_hedgehog__prompt_kernel
.p2align 8
.type concat_heads__mha_block__linear_kernel_hedgehog__prompt_kernel,@function
concat_heads__mha_block__linear_kernel_hedgehog__prompt_kernel:
    s_getpc_b64 s[84:85]
    s_mov_b32 s86, ALL_END-concat_heads__mha_block__linear_kernel_hedgehog__prompt_kernel-8
    s_mov_b32 s87, 0x20000
    v_lshlrev_b32 v1, 7, v0
    buffer_load_dword v208, v1, s[84:87], 0 offen
    s_cmp_ge_u32 s2, 0x100
    s_cbranch_scc1 K3_END
    s_load_dwordx4 s[4:7], s[0:1], 0
    s_load_dwordx4 s[8:11], s[0:1], 24
    s_load_dwordx2 s[12:13], s[0:1], 72
    s_and_b32 s3, s2, 7
    s_lshr_b32 s14, s2, 3
    s_lshr_b32 s28, s3, 2
    s_and_b32 s29, s3, 1
    s_lshl_b32 s29, s29, 2
    s_and_b32 s15, s14, 3
    s_add_u32 s29, s29, s15
    s_bfe_u32 s30, s3, 0x10001
    s_lshl_b32 s30, s30, 3
    s_lshr_b32 s15, s14, 2
    s_add_u32 s30, s30, s15
    s_load_dwordx4 s[96:99], s[0:1], 64
    s_memrealtime s[88:89]
    s_mul_i32 s31, s30, 205
    s_lshr_b32 s31, s31, 10
    s_mul_i32 s15, s31, 5
    s_sub_u32 s32, s30, s15
    v_lshrrev_b32 v1, 6, v0
    v_and_b32 v0, 63, v0
    v_readfirstlane_b32 s33, v1
    s_waitcnt lgkmcnt(0)
    s_cmp_eq_u32 s28, 0
    s_cselect_b32 s4, s4, s8
    s_cselect_b32 s5, s5, s9
    s_cselect_b32 s6, s6, s10
    s_cselect_b32 s7, s7, s11
    s_mov_b32 s16, s4
    s_mov_b32 s17, s5
    s_mov_b32 s18, 2621440
    s_mov_b32 s19, 0x20000
    s_mov_b32 s20, s6
    s_mov_b32 s21, s7
    s_mov_b32 s22, 2457600
    s_mov_b32 s23, 0x20000
    s_mov_b32 s24, s12
    s_mov_b32 s25, s13
    s_mov_b32 s26, 24117248
    s_mov_b32 s27, 0x20000
    s_mov_b32 s90, s33
    s_or_b32 s91, s88, 1
    s_mov_b32 s92, s96
    s_mov_b32 s93, s97
    s_mov_b32 s94, 256
    s_mov_b32 s95, 0x20000
    s_mov_b32 s96, s98
    s_mov_b32 s97, s99
    s_mov_b32 s98, 24117248
    s_mov_b32 s99, 0x20000
    s_cmp_lg_u32 s33, 0
    s_cbranch_scc1 K1_NN
    s_nop 0
    v_mov_b32 v210, s91
    v_mov_b32 v211, 0
    v_mov_b32 v209, 0xfc
    s_mov_b64 exec, 1
    buffer_atomic_cmpswap v[210:211], v209, s[92:95], 0 offen sc0 sc1
    s_mov_b64 exec, -1
K1_NN:
    s_cmp_eq_u32 s30, 15
    s_cbranch_scc1 K1_PF
    s_cmp_lt_u32 s33, 4
    s_cbranch_scc1 K1_COMP
    s_sub_u32 s33, s33, 4
    s_lshl_b32 s34, s29, 8
    s_lshl_b32 s35, s33, 6
    s_add_u32 s34, s34, s35
    v_lshrrev_b32 v1, 3, v0
    v_add_u32 v1, s34, v1
    v_mul_u32_u24 v1, 0x500, v1
    v_lshrrev_b32 v2, 4, v0
    v_and_b32 v3, 7, v0
    v_xor_b32 v3, v3, v2
    v_lshl_add_u32 v4, v3, 4, v1
    v_xor_b32 v3, 4, v3
    v_lshl_add_u32 v5, v3, 4, v1
    s_lshl_b32 s35, s33, 4
    v_add_u32 v1, s35, v2
    v_mul_u32_u24 v1, 0xf00, v1
    v_and_b32 v3, 15, v0
    v_lshlrev_b32 v2, 2, v2
    v_xor_b32 v3, v3, v2
    v_lshl_add_u32 v6, v3, 4, v1
    s_lshl_b32 s35, s30, 8
    v_add_u32 v6, s35, v6
    s_lshl_b32 s36, s33, 13
    s_lshl_b32 s37, s33, 12
    s_add_u32 s37, s37, 0x8000
    s_mov_b32 s38, 0
    s_bfe_u32 s39, s2, 0x20003
    s_mul_i32 s39, s39, 5
    s_lshr_b32 s39, s39, 1
    s_lshr_b32 s40, s2, 5
    s_mul_i32 s40, s40, 1
    s_add_u32 s39, s39, s40
    s_mul_i32 s40, s39, 205
    s_lshr_b32 s40, s40, 11
    s_mul_i32 s40, s40, 10
    s_sub_u32 s39, s39, s40
    s_mul_i32 s40, s39, 245760
    s_lshl_b32 s39, s39, 7
    s_mov_b32 s41, 0
K1_LD:
    s_add_u32 s42, s41, s36
    s_mov_b32 s43, s39
    s_mov_b32 m0, s42
    s_nop 0
    buffer_load_dwordx4 v4, s[16:19], s43 offen lds
    s_add_u32 s42, s42, 0x400
    s_add_u32 s43, s43, 0x2800
    s_mov_b32 m0, s42
    s_nop 0
    buffer_load_dwordx4 v5, s[16:19], s43 offen lds
    s_add_u32 s42, s42, 0x400
    s_add_u32 s43, s43, 0x2800
    s_mov_b32 m0, s42
    s_nop 0
    buffer_load_dwordx4 v4, s[16:19], s43 offen lds
    s_add_u32 s42, s42, 0x400
    s_add_u32 s43, s43, 0x2800
    s_mov_b32 m0, s42
    s_nop 0
    buffer_load_dwordx4 v5, s[16:19], s43 offen lds
    s_add_u32 s42, s42, 0x400
    s_add_u32 s43, s43, 0x2800
    s_mov_b32 m0, s42
    s_nop 0
    buffer_load_dwordx4 v4, s[16:19], s43 offen lds
    s_add_u32 s42, s42, 0x400
    s_add_u32 s43, s43, 0x2800
    s_mov_b32 m0, s42
    s_nop 0
    buffer_load_dwordx4 v5, s[16:19], s43 offen lds
    s_add_u32 s42, s42, 0x400
    s_add_u32 s43, s43, 0x2800
    s_mov_b32 m0, s42
    s_nop 0
    buffer_load_dwordx4 v4, s[16:19], s43 offen lds
    s_add_u32 s42, s42, 0x400
    s_add_u32 s43, s43, 0x2800
    s_mov_b32 m0, s42
    s_nop 0
    buffer_load_dwordx4 v5, s[16:19], s43 offen lds
    s_add_u32 s42, s41, s37
    s_mov_b32 s43, s40
    s_mov_b32 m0, s42
    s_nop 0
    buffer_load_dwordx4 v6, s[20:23], s43 offen lds
    s_add_u32 s42, s42, 0x400
    s_add_u32 s43, s43, 0x3c00
    s_mov_b32 m0, s42
    s_nop 0
    buffer_load_dwordx4 v6, s[20:23], s43 offen lds
    s_add_u32 s42, s42, 0x400
    s_add_u32 s43, s43, 0x3c00
    s_mov_b32 m0, s42
    s_nop 0
    buffer_load_dwordx4 v6, s[20:23], s43 offen lds
    s_add_u32 s42, s42, 0x400
    s_add_u32 s43, s43, 0x3c00
    s_mov_b32 m0, s42
    s_nop 0
    buffer_load_dwordx4 v6, s[20:23], s43 offen lds
    s_add_u32 s39, s39, 0x80
    s_add_u32 s40, s40, 245760
    s_cmp_eq_u32 s39, 0x500
    s_cselect_b32 s39, 0, s39
    s_cselect_b32 s40, 0, s40
    s_add_u32 s41, s41, 49152
    s_cmp_eq_u32 s41, 147456
    s_cselect_b32 s41, 0, s41
    s_add_u32 s38, s38, 1
    s_cmp_lt_u32 s38, 3
    s_cbranch_scc1 K1_LD
    s_cmp_gt_u32 s38, 3
    s_cbranch_scc1 K1_LD2
    s_waitcnt vmcnt(24)
    s_barrier
K1_LD2:
    s_waitcnt vmcnt(12)
    s_barrier
    s_cmp_lt_u32 s38, 10
    s_cbranch_scc1 K1_LD
    s_waitcnt vmcnt(0)
    s_barrier
K1_PF:
    s_cmp_lt_u32 s90, 4
    s_cbranch_scc1 K1_DONE
    s_cmp_lg_u32 s90, 4
    s_cbranch_scc1 K1_PF2
    s_nop 0
K1_PF2:
    s_load_dwordx2 s[4:5], s[0:1], 16
    s_load_dwordx4 s[8:11], s[0:1], 40
    s_lshr_b32 s14, s2, 3
    s_lshl_b32 s14, s14, 2
    s_add_u32 s14, s14, s90
    s_sub_u32 s14, s14, 4
    s_mul_i32 s14, s14, 6400
    s_lshr_b32 s15, s2, 6
    s_lshl_b32 s15, s15, 3
    s_add_u32 s15, s15, s3
    s_mul_i32 s15, s15, 800
    v_lshlrev_b32 v1, 7, v0
    s_waitcnt lgkmcnt(0)
    s_mov_b32 s16, s10
    s_mov_b32 s17, s11
    s_mov_b32 s18, 819200
    s_mov_b32 s19, 0x20000
    s_mov_b32 s6, 819200
    s_mov_b32 s7, 0x20000
    s_mov_b32 s10, 25600
    s_mov_b32 s11, 0x20000
    s_mov_b64 exec, 0xff
    buffer_load_dword v250, v1, s[8:11], s15 offen
    s_mov_b64 exec, -1
    buffer_load_dword v250, v1, s[4:7], s14 offen
    buffer_load_dword v251, v1, s[16:19], s14 offen
    s_branch K1_DONE
K1_COMP:
    v_and_b32 v1, 31, v0
    v_lshrrev_b32 v2, 5, v0
    s_lshl_b32 s34, s33, 13
    v_lshlrev_b32 v3, 7, v1
    v_add_u32 v3, s34, v3
    v_bfe_u32 v4, v1, 1, 3
    v_or_b32 v5, 0, v2
    v_xor_b32 v5, v5, v4
    v_lshl_add_u32 v8, v5, 4, v3
    v_or_b32 v5, 2, v2
    v_xor_b32 v5, v5, v4
    v_lshl_add_u32 v9, v5, 4, v3
    v_or_b32 v5, 4, v2
    v_xor_b32 v5, v5, v4
    v_lshl_add_u32 v10, v5, 4, v3
    v_or_b32 v5, 6, v2
    v_xor_b32 v5, v5, v4
    v_lshl_add_u32 v11, v5, 4, v3
    v_mov_b32 v80, 0
    v_mov_b32 v81, 0
    v_mov_b32 v82, 0
    v_mov_b32 v83, 0
    v_mov_b32 v84, 0
    v_mov_b32 v85, 0
    v_mov_b32 v86, 0
    v_mov_b32 v87, 0
    v_mov_b32 v88, 0
    v_mov_b32 v89, 0
    v_mov_b32 v90, 0
    v_mov_b32 v91, 0
    v_mov_b32 v92, 0
    v_mov_b32 v93, 0
    v_mov_b32 v94, 0
    v_mov_b32 v95, 0
    v_mov_b32 v96, 0
    v_mov_b32 v97, 0
    v_mov_b32 v98, 0
    v_mov_b32 v99, 0
    v_mov_b32 v100, 0
    v_mov_b32 v101, 0
    v_mov_b32 v102, 0
    v_mov_b32 v103, 0
    v_mov_b32 v104, 0
    v_mov_b32 v105, 0
    v_mov_b32 v106, 0
    v_mov_b32 v107, 0
    v_mov_b32 v108, 0
    v_mov_b32 v109, 0
    v_mov_b32 v110, 0
    v_mov_b32 v111, 0
    v_mov_b32 v112, 0
    v_mov_b32 v113, 0
    v_mov_b32 v114, 0
    v_mov_b32 v115, 0
    v_mov_b32 v116, 0
    v_mov_b32 v117, 0
    v_mov_b32 v118, 0
    v_mov_b32 v119, 0
    v_mov_b32 v120, 0
    v_mov_b32 v121, 0
    v_mov_b32 v122, 0
    v_mov_b32 v123, 0
    v_mov_b32 v124, 0
    v_mov_b32 v125, 0
    v_mov_b32 v126, 0
    v_mov_b32 v127, 0
    v_mov_b32 v128, 0
    v_mov_b32 v129, 0
    v_mov_b32 v130, 0
    v_mov_b32 v131, 0
    v_mov_b32 v132, 0
    v_mov_b32 v133, 0
    v_mov_b32 v134, 0
    v_mov_b32 v135, 0
    v_mov_b32 v136, 0
    v_mov_b32 v137, 0
    v_mov_b32 v138, 0
    v_mov_b32 v139, 0
    v_mov_b32 v140, 0
    v_mov_b32 v141, 0
    v_mov_b32 v142, 0
    v_mov_b32 v143, 0
    v_mov_b32 v144, 0
    v_mov_b32 v145, 0
    v_mov_b32 v146, 0
    v_mov_b32 v147, 0
    v_mov_b32 v148, 0
    v_mov_b32 v149, 0
    v_mov_b32 v150, 0
    v_mov_b32 v151, 0
    v_mov_b32 v152, 0
    v_mov_b32 v153, 0
    v_mov_b32 v154, 0
    v_mov_b32 v155, 0
    v_mov_b32 v156, 0
    v_mov_b32 v157, 0
    v_mov_b32 v158, 0
    v_mov_b32 v159, 0
    v_mov_b32 v160, 0
    v_mov_b32 v161, 0
    v_mov_b32 v162, 0
    v_mov_b32 v163, 0
    v_mov_b32 v164, 0
    v_mov_b32 v165, 0
    v_mov_b32 v166, 0
    v_mov_b32 v167, 0
    v_mov_b32 v168, 0
    v_mov_b32 v169, 0
    v_mov_b32 v170, 0
    v_mov_b32 v171, 0
    v_mov_b32 v172, 0
    v_mov_b32 v173, 0
    v_mov_b32 v174, 0
    v_mov_b32 v175, 0
    v_mov_b32 v176, 0
    v_mov_b32 v177, 0
    v_mov_b32 v178, 0
    v_mov_b32 v179, 0
    v_mov_b32 v180, 0
    v_mov_b32 v181, 0
    v_mov_b32 v182, 0
    v_mov_b32 v183, 0
    v_mov_b32 v184, 0
    v_mov_b32 v185, 0
    v_mov_b32 v186, 0
    v_mov_b32 v187, 0
    v_mov_b32 v188, 0
    v_mov_b32 v189, 0
    v_mov_b32 v190, 0
    v_mov_b32 v191, 0
    v_mov_b32 v192, 0
    v_mov_b32 v193, 0
    v_mov_b32 v194, 0
    v_mov_b32 v195, 0
    v_mov_b32 v196, 0
    v_mov_b32 v197, 0
    v_mov_b32 v198, 0
    v_mov_b32 v199, 0
    v_mov_b32 v200, 0
    v_mov_b32 v201, 0
    v_mov_b32 v202, 0
    v_mov_b32 v203, 0
    v_mov_b32 v204, 0
    v_mov_b32 v205, 0
    v_mov_b32 v206, 0
    v_mov_b32 v207, 0
    s_lshl_b32 s34, s29, 3
    s_lshl_b32 s35, s33, 1
    s_add_u32 s34, s34, s35
    s_lshl_b32 s35, s28, 10
    s_add_u32 s34, s34, s35
    s_cmp_eq_u32 s31, 0
    s_mov_b32 s46, 0x1400
    s_mov_b32 s51, 49152
    s_cselect_b32 s46, 0xa00, s46
    s_cselect_b32 s47, 0, 5242880
    s_mul_i32 s44, s34, s46
    s_add_u32 s44, s44, s47
    s_add_u32 s45, s44, s46
    s_lshl_b32 s46, s46, 6
    s_mov_b32 s52, 0x32410
    s_mov_b32 s48, 0
    s_mov_b32 s49, 0
    s_cmp_eq_u32 s31, 2
    s_cbranch_scc1 K1_V
    v_bfe_u32 v4, v0, 2, 2
    v_lshl_add_u32 v3, v2, 3, v4
    v_lshlrev_b32 v3, 8, v3
    v_bfe_u32 v5, v0, 4, 1
    v_lshl_add_u32 v3, v5, 5, v3
    v_add_u32 v3, 0x8000, v3
    v_and_b32 v5, 1, v0
    v_lshl_add_u32 v3, v5, 4, v3
    v_bfe_u32 v5, v0, 1, 1
    v_lshl_add_u32 v3, v5, 3, v3
    v_xor_b32 v5, 0, v4
    v_lshl_add_u32 v12, v5, 6, v3
    v_xor_b32 v5, 1, v4
    v_lshl_add_u32 v13, v5, 6, v3
    v_xor_b32 v5, 2, v4
    v_lshl_add_u32 v14, v5, 6, v3
    v_xor_b32 v5, 3, v4
    v_lshl_add_u32 v15, v5, 6, v3
    s_lshl_b32 s34, s32, 4
    v_add_u32 v3, s34, v2
    v_lshlrev_b32 v6, 4, v1
    v_add_u32 v4, 0, v3
    v_mul_u32_u24 v5, 0xcd, v4
    v_lshrrev_b32 v5, 10, v5
    v_mul_lo_u32 v16, v5, s46
    v_mul_u32_u24 v5, 5, v5
    v_sub_u32 v4, v4, v5
    v_lshlrev_b32 v4, 2, v4
    v_lshrrev_b32 v4, v4, s52
    v_and_b32 v4, 7, v4
    v_lshl_add_u32 v4, v4, 9, v6
    v_add_u32 v16, v16, v4
    v_add_u32 v4, 2, v3
    v_mul_u32_u24 v5, 0xcd, v4
    v_lshrrev_b32 v5, 10, v5
    v_mul_lo_u32 v17, v5, s46
    v_mul_u32_u24 v5, 5, v5
    v_sub_u32 v4, v4, v5
    v_lshlrev_b32 v4, 2, v4
    v_lshrrev_b32 v4, v4, s52
    v_and_b32 v4, 7, v4
    v_lshl_add_u32 v4, v4, 9, v6
    v_add_u32 v17, v17, v4
    v_add_u32 v4, 4, v3
    v_mul_u32_u24 v5, 0xcd, v4
    v_lshrrev_b32 v5, 10, v5
    v_mul_lo_u32 v18, v5, s46
    v_mul_u32_u24 v5, 5, v5
    v_sub_u32 v4, v4, v5
    v_lshlrev_b32 v4, 2, v4
    v_lshrrev_b32 v4, v4, s52
    v_and_b32 v4, 7, v4
    v_lshl_add_u32 v4, v4, 9, v6
    v_add_u32 v18, v18, v4
    v_add_u32 v4, 6, v3
    v_mul_u32_u24 v5, 0xcd, v4
    v_lshrrev_b32 v5, 10, v5
    v_mul_lo_u32 v19, v5, s46
    v_mul_u32_u24 v5, 5, v5
    v_sub_u32 v4, v4, v5
    v_lshlrev_b32 v4, 2, v4
    v_lshrrev_b32 v4, v4, s52
    v_and_b32 v4, 7, v4
    v_lshl_add_u32 v4, v4, 9, v6
    v_add_u32 v19, v19, v4
    v_add_u32 v4, 8, v3
    v_mul_u32_u24 v5, 0xcd, v4
    v_lshrrev_b32 v5, 10, v5
    v_mul_lo_u32 v20, v5, s46
    v_mul_u32_u24 v5, 5, v5
    v_sub_u32 v4, v4, v5
    v_lshlrev_b32 v4, 2, v4
    v_lshrrev_b32 v4, v4, s52
    v_and_b32 v4, 7, v4
    v_lshl_add_u32 v4, v4, 9, v6
    v_add_u32 v20, v20, v4
    v_add_u32 v4, 10, v3
    v_mul_u32_u24 v5, 0xcd, v4
    v_lshrrev_b32 v5, 10, v5
    v_mul_lo_u32 v21, v5, s46
    v_mul_u32_u24 v5, 5, v5
    v_sub_u32 v4, v4, v5
    v_lshlrev_b32 v4, 2, v4
    v_lshrrev_b32 v4, v4, s52
    v_and_b32 v4, 7, v4
    v_lshl_add_u32 v4, v4, 9, v6
    v_add_u32 v21, v21, v4
    v_add_u32 v4, 12, v3
    v_mul_u32_u24 v5, 0xcd, v4
    v_lshrrev_b32 v5, 10, v5
    v_mul_lo_u32 v22, v5, s46
    v_mul_u32_u24 v5, 5, v5
    v_sub_u32 v4, v4, v5
    v_lshlrev_b32 v4, 2, v4
    v_lshrrev_b32 v4, v4, s52
    v_and_b32 v4, 7, v4
    v_lshl_add_u32 v4, v4, 9, v6
    v_add_u32 v22, v22, v4
    v_add_u32 v4, 14, v3
    v_mul_u32_u24 v5, 0xcd, v4
    v_lshrrev_b32 v5, 10, v5
    v_mul_lo_u32 v23, v5, s46
    v_mul_u32_u24 v5, 5, v5
    v_sub_u32 v4, v4, v5
    v_lshlrev_b32 v4, 2, v4
    v_lshrrev_b32 v4, v4, s52
    v_and_b32 v4, 7, v4
    v_lshl_add_u32 v4, v4, 9, v6
    v_add_u32 v23, v23, v4
    s_cmp_eq_u32 s31, 0
    s_cselect_b32 s34, 1051011932, 1.0
    s_cmp_eq_u32 s28, 0
    s_cselect_b32 s34, s34, 1069066811
    v_mov_b32 v6, s34
    v_mov_b32 v7, s34
    s_barrier
    ds_read_b128 v[32:35], v8 offset:0
    ds_read_b128 v[36:39], v8 offset:4096
    ds_read_b64_tr_b16 v[40:41], v12 offset:0
    ds_read_b64_tr_b16 v[42:43], v12 offset:1024
    ds_read_b64_tr_b16 v[44:45], v13 offset:0
    ds_read_b64_tr_b16 v[46:47], v13 offset:1024
    ds_read_b64_tr_b16 v[48:49], v14 offset:0
    ds_read_b64_tr_b16 v[50:51], v14 offset:1024
    ds_read_b64_tr_b16 v[52:53], v15 offset:0
    ds_read_b64_tr_b16 v[54:55], v15 offset:1024
K1_QL:
    s_waitcnt lgkmcnt(0)
    v_mfma_f32_32x32x16_bf16 v[80:95], v[40:43], v[32:35], v[80:95]
    ds_read_b128 v[56:59], v9 offset:0
    ds_read_b128 v[60:63], v9 offset:4096
    v_mfma_f32_32x32x16_bf16 v[96:111], v[40:43], v[36:39], v[96:111]
    ds_read_b64_tr_b16 v[64:65], v12 offset:4096
    ds_read_b64_tr_b16 v[66:67], v12 offset:5120
    v_mfma_f32_32x32x16_bf16 v[112:127], v[44:47], v[32:35], v[112:127]
    ds_read_b64_tr_b16 v[68:69], v13 offset:4096
    ds_read_b64_tr_b16 v[70:71], v13 offset:5120
    v_mfma_f32_32x32x16_bf16 v[128:143], v[44:47], v[36:39], v[128:143]
    ds_read_b64_tr_b16 v[72:73], v14 offset:4096
    ds_read_b64_tr_b16 v[74:75], v14 offset:5120
    v_mfma_f32_32x32x16_bf16 v[144:159], v[48:51], v[32:35], v[144:159]
    ds_read_b64_tr_b16 v[76:77], v15 offset:4096
    ds_read_b64_tr_b16 v[78:79], v15 offset:5120
    v_mfma_f32_32x32x16_bf16 v[160:175], v[48:51], v[36:39], v[160:175]
    v_mfma_f32_32x32x16_bf16 v[176:191], v[52:55], v[32:35], v[176:191]
    v_mfma_f32_32x32x16_bf16 v[192:207], v[52:55], v[36:39], v[192:207]
    s_waitcnt lgkmcnt(0)
    v_mfma_f32_32x32x16_bf16 v[80:95], v[64:67], v[56:59], v[80:95]
    ds_read_b128 v[32:35], v10 offset:0
    ds_read_b128 v[36:39], v10 offset:4096
    v_mfma_f32_32x32x16_bf16 v[96:111], v[64:67], v[60:63], v[96:111]
    ds_read_b64_tr_b16 v[40:41], v12 offset:8192
    ds_read_b64_tr_b16 v[42:43], v12 offset:9216
    v_mfma_f32_32x32x16_bf16 v[112:127], v[68:71], v[56:59], v[112:127]
    ds_read_b64_tr_b16 v[44:45], v13 offset:8192
    ds_read_b64_tr_b16 v[46:47], v13 offset:9216
    v_mfma_f32_32x32x16_bf16 v[128:143], v[68:71], v[60:63], v[128:143]
    ds_read_b64_tr_b16 v[48:49], v14 offset:8192
    ds_read_b64_tr_b16 v[50:51], v14 offset:9216
    v_mfma_f32_32x32x16_bf16 v[144:159], v[72:75], v[56:59], v[144:159]
    ds_read_b64_tr_b16 v[52:53], v15 offset:8192
    ds_read_b64_tr_b16 v[54:55], v15 offset:9216
    v_mfma_f32_32x32x16_bf16 v[160:175], v[72:75], v[60:63], v[160:175]
    v_mfma_f32_32x32x16_bf16 v[176:191], v[76:79], v[56:59], v[176:191]
    v_mfma_f32_32x32x16_bf16 v[192:207], v[76:79], v[60:63], v[192:207]
    s_waitcnt lgkmcnt(0)
    v_mfma_f32_32x32x16_bf16 v[80:95], v[40:43], v[32:35], v[80:95]
    ds_read_b128 v[56:59], v11 offset:0
    ds_read_b128 v[60:63], v11 offset:4096
    v_mfma_f32_32x32x16_bf16 v[96:111], v[40:43], v[36:39], v[96:111]
    ds_read_b64_tr_b16 v[64:65], v12 offset:12288
    ds_read_b64_tr_b16 v[66:67], v12 offset:13312
    v_mfma_f32_32x32x16_bf16 v[112:127], v[44:47], v[32:35], v[112:127]
    ds_read_b64_tr_b16 v[68:69], v13 offset:12288
    ds_read_b64_tr_b16 v[70:71], v13 offset:13312
    v_mfma_f32_32x32x16_bf16 v[128:143], v[44:47], v[36:39], v[128:143]
    ds_read_b64_tr_b16 v[72:73], v14 offset:12288
    ds_read_b64_tr_b16 v[74:75], v14 offset:13312
    v_mfma_f32_32x32x16_bf16 v[144:159], v[48:51], v[32:35], v[144:159]
    ds_read_b64_tr_b16 v[76:77], v15 offset:12288
    ds_read_b64_tr_b16 v[78:79], v15 offset:13312
    v_mfma_f32_32x32x16_bf16 v[160:175], v[48:51], v[36:39], v[160:175]
    v_mfma_f32_32x32x16_bf16 v[176:191], v[52:55], v[32:35], v[176:191]
    v_mfma_f32_32x32x16_bf16 v[192:207], v[52:55], v[36:39], v[192:207]
    s_waitcnt lgkmcnt(0)
    v_mfma_f32_32x32x16_bf16 v[80:95], v[64:67], v[56:59], v[80:95]
    s_add_u32 s48, s48, 1
    s_cmp_eq_u32 s48, 3
    s_cselect_b32 s50, 4294868992, s51
    s_cselect_b32 s48, 0, s48
    v_add_u32 v8, s50, v8
    v_add_u32 v9, s50, v9
    v_add_u32 v10, s50, v10
    v_add_u32 v11, s50, v11
    v_add_u32 v12, s50, v12
    v_add_u32 v13, s50, v13
    v_add_u32 v14, s50, v14
    v_add_u32 v15, s50, v15
    v_mfma_f32_32x32x16_bf16 v[96:111], v[64:67], v[60:63], v[96:111]
    s_barrier
    v_mfma_f32_32x32x16_bf16 v[112:127], v[68:71], v[56:59], v[112:127]
    ds_read_b128 v[32:35], v8 offset:0
    ds_read_b128 v[36:39], v8 offset:4096
    v_mfma_f32_32x32x16_bf16 v[128:143], v[68:71], v[60:63], v[128:143]
    ds_read_b64_tr_b16 v[40:41], v12 offset:0
    ds_read_b64_tr_b16 v[42:43], v12 offset:1024
    v_mfma_f32_32x32x16_bf16 v[144:159], v[72:75], v[56:59], v[144:159]
    ds_read_b64_tr_b16 v[44:45], v13 offset:0
    ds_read_b64_tr_b16 v[46:47], v13 offset:1024
    v_mfma_f32_32x32x16_bf16 v[160:175], v[72:75], v[60:63], v[160:175]
    ds_read_b64_tr_b16 v[48:49], v14 offset:0
    ds_read_b64_tr_b16 v[50:51], v14 offset:1024
    v_mfma_f32_32x32x16_bf16 v[176:191], v[76:79], v[56:59], v[176:191]
    ds_read_b64_tr_b16 v[52:53], v15 offset:0
    ds_read_b64_tr_b16 v[54:55], v15 offset:1024
    v_mfma_f32_32x32x16_bf16 v[192:207], v[76:79], v[60:63], v[192:207]
    s_add_u32 s49, s49, 1
    s_cmp_lt_u32 s49, 9
    s_cbranch_scc1 K1_QL
    s_waitcnt lgkmcnt(0)
    v_mfma_f32_32x32x16_bf16 v[80:95], v[40:43], v[32:35], v[80:95]
    ds_read_b128 v[56:59], v9 offset:0
    ds_read_b128 v[60:63], v9 offset:4096
    v_mfma_f32_32x32x16_bf16 v[96:111], v[40:43], v[36:39], v[96:111]
    ds_read_b64_tr_b16 v[64:65], v12 offset:4096
    ds_read_b64_tr_b16 v[66:67], v12 offset:5120
    v_mfma_f32_32x32x16_bf16 v[112:127], v[44:47], v[32:35], v[112:127]
    ds_read_b64_tr_b16 v[68:69], v13 offset:4096
    ds_read_b64_tr_b16 v[70:71], v13 offset:5120
    v_mfma_f32_32x32x16_bf16 v[128:143], v[44:47], v[36:39], v[128:143]
    ds_read_b64_tr_b16 v[72:73], v14 offset:4096
    ds_read_b64_tr_b16 v[74:75], v14 offset:5120
    v_mfma_f32_32x32x16_bf16 v[144:159], v[48:51], v[32:35], v[144:159]
    ds_read_b64_tr_b16 v[76:77], v15 offset:4096
    ds_read_b64_tr_b16 v[78:79], v15 offset:5120
    v_mfma_f32_32x32x16_bf16 v[160:175], v[48:51], v[36:39], v[160:175]
    v_mfma_f32_32x32x16_bf16 v[176:191], v[52:55], v[32:35], v[176:191]
    v_mfma_f32_32x32x16_bf16 v[192:207], v[52:55], v[36:39], v[192:207]
    s_waitcnt lgkmcnt(0)
    v_mfma_f32_32x32x16_bf16 v[80:95], v[64:67], v[56:59], v[80:95]
    ds_read_b128 v[32:35], v10 offset:0
    ds_read_b128 v[36:39], v10 offset:4096
    v_mfma_f32_32x32x16_bf16 v[96:111], v[64:67], v[60:63], v[96:111]
    ds_read_b64_tr_b16 v[40:41], v12 offset:8192
    ds_read_b64_tr_b16 v[42:43], v12 offset:9216
    v_mfma_f32_32x32x16_bf16 v[112:127], v[68:71], v[56:59], v[112:127]
    ds_read_b64_tr_b16 v[44:45], v13 offset:8192
    ds_read_b64_tr_b16 v[46:47], v13 offset:9216
    v_mfma_f32_32x32x16_bf16 v[128:143], v[68:71], v[60:63], v[128:143]
    ds_read_b64_tr_b16 v[48:49], v14 offset:8192
    ds_read_b64_tr_b16 v[50:51], v14 offset:9216
    v_mfma_f32_32x32x16_bf16 v[144:159], v[72:75], v[56:59], v[144:159]
    ds_read_b64_tr_b16 v[52:53], v15 offset:8192
    ds_read_b64_tr_b16 v[54:55], v15 offset:9216
    v_mfma_f32_32x32x16_bf16 v[160:175], v[72:75], v[60:63], v[160:175]
    v_mfma_f32_32x32x16_bf16 v[176:191], v[76:79], v[56:59], v[176:191]
    v_mfma_f32_32x32x16_bf16 v[192:207], v[76:79], v[60:63], v[192:207]
    s_waitcnt lgkmcnt(0)
    v_mfma_f32_32x32x16_bf16 v[80:95], v[40:43], v[32:35], v[80:95]
    ds_read_b128 v[56:59], v11 offset:0
    ds_read_b128 v[60:63], v11 offset:4096
    v_mfma_f32_32x32x16_bf16 v[96:111], v[40:43], v[36:39], v[96:111]
    ds_read_b64_tr_b16 v[64:65], v12 offset:12288
    ds_read_b64_tr_b16 v[66:67], v12 offset:13312
    v_mfma_f32_32x32x16_bf16 v[112:127], v[44:47], v[32:35], v[112:127]
    ds_read_b64_tr_b16 v[68:69], v13 offset:12288
    ds_read_b64_tr_b16 v[70:71], v13 offset:13312
    v_mfma_f32_32x32x16_bf16 v[128:143], v[44:47], v[36:39], v[128:143]
    ds_read_b64_tr_b16 v[72:73], v14 offset:12288
    ds_read_b64_tr_b16 v[74:75], v14 offset:13312
    v_mfma_f32_32x32x16_bf16 v[144:159], v[48:51], v[32:35], v[144:159]
    ds_read_b64_tr_b16 v[76:77], v15 offset:12288
    ds_read_b64_tr_b16 v[78:79], v15 offset:13312
    v_mfma_f32_32x32x16_bf16 v[160:175], v[48:51], v[36:39], v[160:175]
    v_mfma_f32_32x32x16_bf16 v[176:191], v[52:55], v[32:35], v[176:191]
    v_mfma_f32_32x32x16_bf16 v[192:207], v[52:55], v[36:39], v[192:207]
    s_waitcnt lgkmcnt(0)
    v_mfma_f32_32x32x16_bf16 v[80:95], v[64:67], v[56:59], v[80:95]
    v_mfma_f32_32x32x16_bf16 v[96:111], v[64:67], v[60:63], v[96:111]
    v_mfma_f32_32x32x16_bf16 v[112:127], v[68:71], v[56:59], v[112:127]
    v_mfma_f32_32x32x16_bf16 v[128:143], v[68:71], v[60:63], v[128:143]
    v_mfma_f32_32x32x16_bf16 v[144:159], v[72:75], v[56:59], v[144:159]
    v_mfma_f32_32x32x16_bf16 v[160:175], v[72:75], v[60:63], v[160:175]
    v_mfma_f32_32x32x16_bf16 v[176:191], v[76:79], v[56:59], v[176:191]
    v_mfma_f32_32x32x16_bf16 v[192:207], v[76:79], v[60:63], v[192:207]
    s_nop 4
    v_pk_mul_f32 v[80:81], v[80:81], v[6:7]
    v_pk_mul_f32 v[82:83], v[82:83], v[6:7]
    v_pk_mul_f32 v[84:85], v[84:85], v[6:7]
    v_pk_mul_f32 v[86:87], v[86:87], v[6:7]
    v_cvt_pk_bf16_f32 v32, v80, v81
    v_cvt_pk_bf16_f32 v33, v82, v83
    v_cvt_pk_bf16_f32 v34, v84, v85
    v_cvt_pk_bf16_f32 v35, v86, v87
    buffer_store_dwordx4 v[32:35], v16, s[24:27], s44 offen sc1
    v_pk_mul_f32 v[88:89], v[88:89], v[6:7]
    v_pk_mul_f32 v[90:91], v[90:91], v[6:7]
    v_pk_mul_f32 v[92:93], v[92:93], v[6:7]
    v_pk_mul_f32 v[94:95], v[94:95], v[6:7]
    v_cvt_pk_bf16_f32 v36, v88, v89
    v_cvt_pk_bf16_f32 v37, v90, v91
    v_cvt_pk_bf16_f32 v38, v92, v93
    v_cvt_pk_bf16_f32 v39, v94, v95
    buffer_store_dwordx4 v[36:39], v17, s[24:27], s44 offen sc1
    v_pk_mul_f32 v[96:97], v[96:97], v[6:7]
    v_pk_mul_f32 v[98:99], v[98:99], v[6:7]
    v_pk_mul_f32 v[100:101], v[100:101], v[6:7]
    v_pk_mul_f32 v[102:103], v[102:103], v[6:7]
    v_cvt_pk_bf16_f32 v40, v96, v97
    v_cvt_pk_bf16_f32 v41, v98, v99
    v_cvt_pk_bf16_f32 v42, v100, v101
    v_cvt_pk_bf16_f32 v43, v102, v103
    buffer_store_dwordx4 v[40:43], v16, s[24:27], s45 offen sc1
    v_pk_mul_f32 v[104:105], v[104:105], v[6:7]
    v_pk_mul_f32 v[106:107], v[106:107], v[6:7]
    v_pk_mul_f32 v[108:109], v[108:109], v[6:7]
    v_pk_mul_f32 v[110:111], v[110:111], v[6:7]
    v_cvt_pk_bf16_f32 v44, v104, v105
    v_cvt_pk_bf16_f32 v45, v106, v107
    v_cvt_pk_bf16_f32 v46, v108, v109
    v_cvt_pk_bf16_f32 v47, v110, v111
    buffer_store_dwordx4 v[44:47], v17, s[24:27], s45 offen sc1
    v_pk_mul_f32 v[112:113], v[112:113], v[6:7]
    v_pk_mul_f32 v[114:115], v[114:115], v[6:7]
    v_pk_mul_f32 v[116:117], v[116:117], v[6:7]
    v_pk_mul_f32 v[118:119], v[118:119], v[6:7]
    v_cvt_pk_bf16_f32 v48, v112, v113
    v_cvt_pk_bf16_f32 v49, v114, v115
    v_cvt_pk_bf16_f32 v50, v116, v117
    v_cvt_pk_bf16_f32 v51, v118, v119
    buffer_store_dwordx4 v[48:51], v18, s[24:27], s44 offen sc1
    v_pk_mul_f32 v[120:121], v[120:121], v[6:7]
    v_pk_mul_f32 v[122:123], v[122:123], v[6:7]
    v_pk_mul_f32 v[124:125], v[124:125], v[6:7]
    v_pk_mul_f32 v[126:127], v[126:127], v[6:7]
    v_cvt_pk_bf16_f32 v52, v120, v121
    v_cvt_pk_bf16_f32 v53, v122, v123
    v_cvt_pk_bf16_f32 v54, v124, v125
    v_cvt_pk_bf16_f32 v55, v126, v127
    buffer_store_dwordx4 v[52:55], v19, s[24:27], s44 offen sc1
    v_pk_mul_f32 v[128:129], v[128:129], v[6:7]
    v_pk_mul_f32 v[130:131], v[130:131], v[6:7]
    v_pk_mul_f32 v[132:133], v[132:133], v[6:7]
    v_pk_mul_f32 v[134:135], v[134:135], v[6:7]
    v_cvt_pk_bf16_f32 v56, v128, v129
    v_cvt_pk_bf16_f32 v57, v130, v131
    v_cvt_pk_bf16_f32 v58, v132, v133
    v_cvt_pk_bf16_f32 v59, v134, v135
    buffer_store_dwordx4 v[56:59], v18, s[24:27], s45 offen sc1
    v_pk_mul_f32 v[136:137], v[136:137], v[6:7]
    v_pk_mul_f32 v[138:139], v[138:139], v[6:7]
    v_pk_mul_f32 v[140:141], v[140:141], v[6:7]
    v_pk_mul_f32 v[142:143], v[142:143], v[6:7]
    v_cvt_pk_bf16_f32 v60, v136, v137
    v_cvt_pk_bf16_f32 v61, v138, v139
    v_cvt_pk_bf16_f32 v62, v140, v141
    v_cvt_pk_bf16_f32 v63, v142, v143
    buffer_store_dwordx4 v[60:63], v19, s[24:27], s45 offen sc1
    v_pk_mul_f32 v[144:145], v[144:145], v[6:7]
    v_pk_mul_f32 v[146:147], v[146:147], v[6:7]
    v_pk_mul_f32 v[148:149], v[148:149], v[6:7]
    v_pk_mul_f32 v[150:151], v[150:151], v[6:7]
    v_cvt_pk_bf16_f32 v32, v144, v145
    v_cvt_pk_bf16_f32 v33, v146, v147
    v_cvt_pk_bf16_f32 v34, v148, v149
    v_cvt_pk_bf16_f32 v35, v150, v151
    buffer_store_dwordx4 v[32:35], v20, s[24:27], s44 offen sc1
    v_pk_mul_f32 v[152:153], v[152:153], v[6:7]
    v_pk_mul_f32 v[154:155], v[154:155], v[6:7]
    v_pk_mul_f32 v[156:157], v[156:157], v[6:7]
    v_pk_mul_f32 v[158:159], v[158:159], v[6:7]
    v_cvt_pk_bf16_f32 v36, v152, v153
    v_cvt_pk_bf16_f32 v37, v154, v155
    v_cvt_pk_bf16_f32 v38, v156, v157
    v_cvt_pk_bf16_f32 v39, v158, v159
    buffer_store_dwordx4 v[36:39], v21, s[24:27], s44 offen sc1
    v_pk_mul_f32 v[160:161], v[160:161], v[6:7]
    v_pk_mul_f32 v[162:163], v[162:163], v[6:7]
    v_pk_mul_f32 v[164:165], v[164:165], v[6:7]
    v_pk_mul_f32 v[166:167], v[166:167], v[6:7]
    v_cvt_pk_bf16_f32 v40, v160, v161
    v_cvt_pk_bf16_f32 v41, v162, v163
    v_cvt_pk_bf16_f32 v42, v164, v165
    v_cvt_pk_bf16_f32 v43, v166, v167
    buffer_store_dwordx4 v[40:43], v20, s[24:27], s45 offen sc1
    v_pk_mul_f32 v[168:169], v[168:169], v[6:7]
    v_pk_mul_f32 v[170:171], v[170:171], v[6:7]
    v_pk_mul_f32 v[172:173], v[172:173], v[6:7]
    v_pk_mul_f32 v[174:175], v[174:175], v[6:7]
    v_cvt_pk_bf16_f32 v44, v168, v169
    v_cvt_pk_bf16_f32 v45, v170, v171
    v_cvt_pk_bf16_f32 v46, v172, v173
    v_cvt_pk_bf16_f32 v47, v174, v175
    buffer_store_dwordx4 v[44:47], v21, s[24:27], s45 offen sc1
    v_pk_mul_f32 v[176:177], v[176:177], v[6:7]
    v_pk_mul_f32 v[178:179], v[178:179], v[6:7]
    v_pk_mul_f32 v[180:181], v[180:181], v[6:7]
    v_pk_mul_f32 v[182:183], v[182:183], v[6:7]
    v_cvt_pk_bf16_f32 v48, v176, v177
    v_cvt_pk_bf16_f32 v49, v178, v179
    v_cvt_pk_bf16_f32 v50, v180, v181
    v_cvt_pk_bf16_f32 v51, v182, v183
    buffer_store_dwordx4 v[48:51], v22, s[24:27], s44 offen sc1
    v_pk_mul_f32 v[184:185], v[184:185], v[6:7]
    v_pk_mul_f32 v[186:187], v[186:187], v[6:7]
    v_pk_mul_f32 v[188:189], v[188:189], v[6:7]
    v_pk_mul_f32 v[190:191], v[190:191], v[6:7]
    v_cvt_pk_bf16_f32 v52, v184, v185
    v_cvt_pk_bf16_f32 v53, v186, v187
    v_cvt_pk_bf16_f32 v54, v188, v189
    v_cvt_pk_bf16_f32 v55, v190, v191
    buffer_store_dwordx4 v[52:55], v23, s[24:27], s44 offen sc1
    v_pk_mul_f32 v[192:193], v[192:193], v[6:7]
    v_pk_mul_f32 v[194:195], v[194:195], v[6:7]
    v_pk_mul_f32 v[196:197], v[196:197], v[6:7]
    v_pk_mul_f32 v[198:199], v[198:199], v[6:7]
    v_cvt_pk_bf16_f32 v56, v192, v193
    v_cvt_pk_bf16_f32 v57, v194, v195
    v_cvt_pk_bf16_f32 v58, v196, v197
    v_cvt_pk_bf16_f32 v59, v198, v199
    buffer_store_dwordx4 v[56:59], v22, s[24:27], s45 offen sc1
    v_pk_mul_f32 v[200:201], v[200:201], v[6:7]
    v_pk_mul_f32 v[202:203], v[202:203], v[6:7]
    v_pk_mul_f32 v[204:205], v[204:205], v[6:7]
    v_pk_mul_f32 v[206:207], v[206:207], v[6:7]
    v_cvt_pk_bf16_f32 v60, v200, v201
    v_cvt_pk_bf16_f32 v61, v202, v203
    v_cvt_pk_bf16_f32 v62, v204, v205
    v_cvt_pk_bf16_f32 v63, v206, v207
    buffer_store_dwordx4 v[60:63], v23, s[24:27], s45 offen sc1
    s_branch K1_DONE
K1_V:
    v_bfe_u32 v4, v0, 2, 2
    v_lshl_add_u32 v3, v2, 3, v4
    v_lshlrev_b32 v3, 8, v3
    v_bfe_u32 v5, v0, 4, 1
    v_lshl_add_u32 v3, v5, 5, v3
    v_add_u32 v3, 0x8000, v3
    v_and_b32 v5, 3, v0
    v_lshl_add_u32 v3, v5, 3, v3
    v_xor_b32 v5, 0, v4
    v_lshl_add_u32 v12, v5, 6, v3
    v_xor_b32 v5, 1, v4
    v_lshl_add_u32 v13, v5, 6, v3
    v_xor_b32 v5, 2, v4
    v_lshl_add_u32 v14, v5, 6, v3
    v_xor_b32 v5, 3, v4
    v_lshl_add_u32 v15, v5, 6, v3
    s_lshl_b32 s34, s32, 7
    v_add_u32 v3, s34, v1
    v_mul_u32_u24 v6, 0x140, v2
    v_add_u32 v6, 0xa00, v6
    v_add_u32 v4, 0, v3
    v_mul_u32_u24 v5, 0xccd, v4
    v_lshrrev_b32 v5, 16, v5
    v_lshrrev_b32 v7, 1, v5
    v_mul_lo_u32 v16, v7, s46
    v_and_b32 v7, 1, v5
    v_mul_u32_u24 v7, 0x500, v7
    v_add_u32 v16, v16, v7
    v_mul_u32_u24 v5, 20, v5
    v_sub_u32 v4, v4, v5
    v_and_b32 v5, 19, v4
    v_and_b32 v7, 4, v4
    v_lshl_or_b32 v5, v7, 1, v5
    v_bfe_u32 v7, v4, 3, 1
    v_lshl_or_b32 v5, v7, 2, v5
    v_lshl_add_u32 v5, v5, 4, v6
    v_add_u32 v16, v16, v5
    v_add_u32 v4, 32, v3
    v_mul_u32_u24 v5, 0xccd, v4
    v_lshrrev_b32 v5, 16, v5
    v_lshrrev_b32 v7, 1, v5
    v_mul_lo_u32 v17, v7, s46
    v_and_b32 v7, 1, v5
    v_mul_u32_u24 v7, 0x500, v7
    v_add_u32 v17, v17, v7
    v_mul_u32_u24 v5, 20, v5
    v_sub_u32 v4, v4, v5
    v_and_b32 v5, 19, v4
    v_and_b32 v7, 4, v4
    v_lshl_or_b32 v5, v7, 1, v5
    v_bfe_u32 v7, v4, 3, 1
    v_lshl_or_b32 v5, v7, 2, v5
    v_lshl_add_u32 v5, v5, 4, v6
    v_add_u32 v17, v17, v5
    v_add_u32 v4, 64, v3
    v_mul_u32_u24 v5, 0xccd, v4
    v_lshrrev_b32 v5, 16, v5
    v_lshrrev_b32 v7, 1, v5
    v_mul_lo_u32 v18, v7, s46
    v_and_b32 v7, 1, v5
    v_mul_u32_u24 v7, 0x500, v7
    v_add_u32 v18, v18, v7
    v_mul_u32_u24 v5, 20, v5
    v_sub_u32 v4, v4, v5
    v_and_b32 v5, 19, v4
    v_and_b32 v7, 4, v4
    v_lshl_or_b32 v5, v7, 1, v5
    v_bfe_u32 v7, v4, 3, 1
    v_lshl_or_b32 v5, v7, 2, v5
    v_lshl_add_u32 v5, v5, 4, v6
    v_add_u32 v18, v18, v5
    v_add_u32 v4, 96, v3
    v_mul_u32_u24 v5, 0xccd, v4
    v_lshrrev_b32 v5, 16, v5
    v_lshrrev_b32 v7, 1, v5
    v_mul_lo_u32 v19, v7, s46
    v_and_b32 v7, 1, v5
    v_mul_u32_u24 v7, 0x500, v7
    v_add_u32 v19, v19, v7
    v_mul_u32_u24 v5, 20, v5
    v_sub_u32 v4, v4, v5
    v_and_b32 v5, 19, v4
    v_and_b32 v7, 4, v4
    v_lshl_or_b32 v5, v7, 1, v5
    v_bfe_u32 v7, v4, 3, 1
    v_lshl_or_b32 v5, v7, 2, v5
    v_lshl_add_u32 v5, v5, 4, v6
    v_add_u32 v19, v19, v5
    s_barrier
    ds_read_b128 v[32:35], v8 offset:0
    ds_read_b128 v[36:39], v8 offset:4096
    ds_read_b64_tr_b16 v[40:41], v12 offset:0
    ds_read_b64_tr_b16 v[42:43], v12 offset:1024
    ds_read_b64_tr_b16 v[44:45], v13 offset:0
    ds_read_b64_tr_b16 v[46:47], v13 offset:1024
    ds_read_b64_tr_b16 v[48:49], v14 offset:0
    ds_read_b64_tr_b16 v[50:51], v14 offset:1024
    ds_read_b64_tr_b16 v[52:53], v15 offset:0
    ds_read_b64_tr_b16 v[54:55], v15 offset:1024
K1_VL:
    s_waitcnt lgkmcnt(0)
    v_mfma_f32_32x32x16_bf16 v[80:95], v[32:35], v[40:43], v[80:95]
    ds_read_b128 v[56:59], v9 offset:0
    ds_read_b128 v[60:63], v9 offset:4096
    v_mfma_f32_32x32x16_bf16 v[96:111], v[36:39], v[40:43], v[96:111]
    ds_read_b64_tr_b16 v[64:65], v12 offset:4096
    ds_read_b64_tr_b16 v[66:67], v12 offset:5120
    v_mfma_f32_32x32x16_bf16 v[112:127], v[32:35], v[44:47], v[112:127]
    ds_read_b64_tr_b16 v[68:69], v13 offset:4096
    ds_read_b64_tr_b16 v[70:71], v13 offset:5120
    v_mfma_f32_32x32x16_bf16 v[128:143], v[36:39], v[44:47], v[128:143]
    ds_read_b64_tr_b16 v[72:73], v14 offset:4096
    ds_read_b64_tr_b16 v[74:75], v14 offset:5120
    v_mfma_f32_32x32x16_bf16 v[144:159], v[32:35], v[48:51], v[144:159]
    ds_read_b64_tr_b16 v[76:77], v15 offset:4096
    ds_read_b64_tr_b16 v[78:79], v15 offset:5120
    v_mfma_f32_32x32x16_bf16 v[160:175], v[36:39], v[48:51], v[160:175]
    v_mfma_f32_32x32x16_bf16 v[176:191], v[32:35], v[52:55], v[176:191]
    v_mfma_f32_32x32x16_bf16 v[192:207], v[36:39], v[52:55], v[192:207]
    s_waitcnt lgkmcnt(0)
    v_mfma_f32_32x32x16_bf16 v[80:95], v[56:59], v[64:67], v[80:95]
    ds_read_b128 v[32:35], v10 offset:0
    ds_read_b128 v[36:39], v10 offset:4096
    v_mfma_f32_32x32x16_bf16 v[96:111], v[60:63], v[64:67], v[96:111]
    ds_read_b64_tr_b16 v[40:41], v12 offset:8192
    ds_read_b64_tr_b16 v[42:43], v12 offset:9216
    v_mfma_f32_32x32x16_bf16 v[112:127], v[56:59], v[68:71], v[112:127]
    ds_read_b64_tr_b16 v[44:45], v13 offset:8192
    ds_read_b64_tr_b16 v[46:47], v13 offset:9216
    v_mfma_f32_32x32x16_bf16 v[128:143], v[60:63], v[68:71], v[128:143]
    ds_read_b64_tr_b16 v[48:49], v14 offset:8192
    ds_read_b64_tr_b16 v[50:51], v14 offset:9216
    v_mfma_f32_32x32x16_bf16 v[144:159], v[56:59], v[72:75], v[144:159]
    ds_read_b64_tr_b16 v[52:53], v15 offset:8192
    ds_read_b64_tr_b16 v[54:55], v15 offset:9216
    v_mfma_f32_32x32x16_bf16 v[160:175], v[60:63], v[72:75], v[160:175]
    v_mfma_f32_32x32x16_bf16 v[176:191], v[56:59], v[76:79], v[176:191]
    v_mfma_f32_32x32x16_bf16 v[192:207], v[60:63], v[76:79], v[192:207]
    s_waitcnt lgkmcnt(0)
    v_mfma_f32_32x32x16_bf16 v[80:95], v[32:35], v[40:43], v[80:95]
    ds_read_b128 v[56:59], v11 offset:0
    ds_read_b128 v[60:63], v11 offset:4096
    v_mfma_f32_32x32x16_bf16 v[96:111], v[36:39], v[40:43], v[96:111]
    ds_read_b64_tr_b16 v[64:65], v12 offset:12288
    ds_read_b64_tr_b16 v[66:67], v12 offset:13312
    v_mfma_f32_32x32x16_bf16 v[112:127], v[32:35], v[44:47], v[112:127]
    ds_read_b64_tr_b16 v[68:69], v13 offset:12288
    ds_read_b64_tr_b16 v[70:71], v13 offset:13312
    v_mfma_f32_32x32x16_bf16 v[128:143], v[36:39], v[44:47], v[128:143]
    ds_read_b64_tr_b16 v[72:73], v14 offset:12288
    ds_read_b64_tr_b16 v[74:75], v14 offset:13312
    v_mfma_f32_32x32x16_bf16 v[144:159], v[32:35], v[48:51], v[144:159]
    ds_read_b64_tr_b16 v[76:77], v15 offset:12288
    ds_read_b64_tr_b16 v[78:79], v15 offset:13312
    v_mfma_f32_32x32x16_bf16 v[160:175], v[36:39], v[48:51], v[160:175]
    v_mfma_f32_32x32x16_bf16 v[176:191], v[32:35], v[52:55], v[176:191]
    v_mfma_f32_32x32x16_bf16 v[192:207], v[36:39], v[52:55], v[192:207]
    s_waitcnt lgkmcnt(0)
    v_mfma_f32_32x32x16_bf16 v[80:95], v[56:59], v[64:67], v[80:95]
    s_add_u32 s48, s48, 1
    s_cmp_eq_u32 s48, 3
    s_cselect_b32 s50, 4294868992, s51
    s_cselect_b32 s48, 0, s48
    v_add_u32 v8, s50, v8
    v_add_u32 v9, s50, v9
    v_add_u32 v10, s50, v10
    v_add_u32 v11, s50, v11
    v_add_u32 v12, s50, v12
    v_add_u32 v13, s50, v13
    v_add_u32 v14, s50, v14
    v_add_u32 v15, s50, v15
    v_mfma_f32_32x32x16_bf16 v[96:111], v[60:63], v[64:67], v[96:111]
    s_barrier
    v_mfma_f32_32x32x16_bf16 v[112:127], v[56:59], v[68:71], v[112:127]
    ds_read_b128 v[32:35], v8 offset:0
    ds_read_b128 v[36:39], v8 offset:4096
    v_mfma_f32_32x32x16_bf16 v[128:143], v[60:63], v[68:71], v[128:143]
    ds_read_b64_tr_b16 v[40:41], v12 offset:0
    ds_read_b64_tr_b16 v[42:43], v12 offset:1024
    v_mfma_f32_32x32x16_bf16 v[144:159], v[56:59], v[72:75], v[144:159]
    ds_read_b64_tr_b16 v[44:45], v13 offset:0
    ds_read_b64_tr_b16 v[46:47], v13 offset:1024
    v_mfma_f32_32x32x16_bf16 v[160:175], v[60:63], v[72:75], v[160:175]
    ds_read_b64_tr_b16 v[48:49], v14 offset:0
    ds_read_b64_tr_b16 v[50:51], v14 offset:1024
    v_mfma_f32_32x32x16_bf16 v[176:191], v[56:59], v[76:79], v[176:191]
    ds_read_b64_tr_b16 v[52:53], v15 offset:0
    ds_read_b64_tr_b16 v[54:55], v15 offset:1024
    v_mfma_f32_32x32x16_bf16 v[192:207], v[60:63], v[76:79], v[192:207]
    s_add_u32 s49, s49, 1
    s_cmp_lt_u32 s49, 9
    s_cbranch_scc1 K1_VL
    s_waitcnt lgkmcnt(0)
    v_mfma_f32_32x32x16_bf16 v[80:95], v[32:35], v[40:43], v[80:95]
    ds_read_b128 v[56:59], v9 offset:0
    ds_read_b128 v[60:63], v9 offset:4096
    v_mfma_f32_32x32x16_bf16 v[96:111], v[36:39], v[40:43], v[96:111]
    ds_read_b64_tr_b16 v[64:65], v12 offset:4096
    ds_read_b64_tr_b16 v[66:67], v12 offset:5120
    v_mfma_f32_32x32x16_bf16 v[112:127], v[32:35], v[44:47], v[112:127]
    ds_read_b64_tr_b16 v[68:69], v13 offset:4096
    ds_read_b64_tr_b16 v[70:71], v13 offset:5120
    v_mfma_f32_32x32x16_bf16 v[128:143], v[36:39], v[44:47], v[128:143]
    ds_read_b64_tr_b16 v[72:73], v14 offset:4096
    ds_read_b64_tr_b16 v[74:75], v14 offset:5120
    v_mfma_f32_32x32x16_bf16 v[144:159], v[32:35], v[48:51], v[144:159]
    ds_read_b64_tr_b16 v[76:77], v15 offset:4096
    ds_read_b64_tr_b16 v[78:79], v15 offset:5120
    v_mfma_f32_32x32x16_bf16 v[160:175], v[36:39], v[48:51], v[160:175]
    v_mfma_f32_32x32x16_bf16 v[176:191], v[32:35], v[52:55], v[176:191]
    v_mfma_f32_32x32x16_bf16 v[192:207], v[36:39], v[52:55], v[192:207]
    s_waitcnt lgkmcnt(0)
    v_mfma_f32_32x32x16_bf16 v[80:95], v[56:59], v[64:67], v[80:95]
    ds_read_b128 v[32:35], v10 offset:0
    ds_read_b128 v[36:39], v10 offset:4096
    v_mfma_f32_32x32x16_bf16 v[96:111], v[60:63], v[64:67], v[96:111]
    ds_read_b64_tr_b16 v[40:41], v12 offset:8192
    ds_read_b64_tr_b16 v[42:43], v12 offset:9216
    v_mfma_f32_32x32x16_bf16 v[112:127], v[56:59], v[68:71], v[112:127]
    ds_read_b64_tr_b16 v[44:45], v13 offset:8192
    ds_read_b64_tr_b16 v[46:47], v13 offset:9216
    v_mfma_f32_32x32x16_bf16 v[128:143], v[60:63], v[68:71], v[128:143]
    ds_read_b64_tr_b16 v[48:49], v14 offset:8192
    ds_read_b64_tr_b16 v[50:51], v14 offset:9216
    v_mfma_f32_32x32x16_bf16 v[144:159], v[56:59], v[72:75], v[144:159]
    ds_read_b64_tr_b16 v[52:53], v15 offset:8192
    ds_read_b64_tr_b16 v[54:55], v15 offset:9216
    v_mfma_f32_32x32x16_bf16 v[160:175], v[60:63], v[72:75], v[160:175]
    v_mfma_f32_32x32x16_bf16 v[176:191], v[56:59], v[76:79], v[176:191]
    v_mfma_f32_32x32x16_bf16 v[192:207], v[60:63], v[76:79], v[192:207]
    s_waitcnt lgkmcnt(0)
    v_mfma_f32_32x32x16_bf16 v[80:95], v[32:35], v[40:43], v[80:95]
    ds_read_b128 v[56:59], v11 offset:0
    ds_read_b128 v[60:63], v11 offset:4096
    v_mfma_f32_32x32x16_bf16 v[96:111], v[36:39], v[40:43], v[96:111]
    ds_read_b64_tr_b16 v[64:65], v12 offset:12288
    ds_read_b64_tr_b16 v[66:67], v12 offset:13312
    v_mfma_f32_32x32x16_bf16 v[112:127], v[32:35], v[44:47], v[112:127]
    ds_read_b64_tr_b16 v[68:69], v13 offset:12288
    ds_read_b64_tr_b16 v[70:71], v13 offset:13312
    v_mfma_f32_32x32x16_bf16 v[128:143], v[36:39], v[44:47], v[128:143]
    ds_read_b64_tr_b16 v[72:73], v14 offset:12288
    ds_read_b64_tr_b16 v[74:75], v14 offset:13312
    v_mfma_f32_32x32x16_bf16 v[144:159], v[32:35], v[48:51], v[144:159]
    ds_read_b64_tr_b16 v[76:77], v15 offset:12288
    ds_read_b64_tr_b16 v[78:79], v15 offset:13312
    v_mfma_f32_32x32x16_bf16 v[160:175], v[36:39], v[48:51], v[160:175]
    v_mfma_f32_32x32x16_bf16 v[176:191], v[32:35], v[52:55], v[176:191]
    v_mfma_f32_32x32x16_bf16 v[192:207], v[36:39], v[52:55], v[192:207]
    s_waitcnt lgkmcnt(0)
    v_mfma_f32_32x32x16_bf16 v[80:95], v[56:59], v[64:67], v[80:95]
    v_mfma_f32_32x32x16_bf16 v[96:111], v[60:63], v[64:67], v[96:111]
    v_mfma_f32_32x32x16_bf16 v[112:127], v[56:59], v[68:71], v[112:127]
    v_mfma_f32_32x32x16_bf16 v[128:143], v[60:63], v[68:71], v[128:143]
    v_mfma_f32_32x32x16_bf16 v[144:159], v[56:59], v[72:75], v[144:159]
    v_mfma_f32_32x32x16_bf16 v[160:175], v[60:63], v[72:75], v[160:175]
    v_mfma_f32_32x32x16_bf16 v[176:191], v[56:59], v[76:79], v[176:191]
    v_mfma_f32_32x32x16_bf16 v[192:207], v[60:63], v[76:79], v[192:207]
    s_nop 4
    v_cvt_pk_bf16_f32 v32, v80, v81
    v_cvt_pk_bf16_f32 v33, v82, v83
    v_cvt_pk_bf16_f32 v34, v84, v85
    v_cvt_pk_bf16_f32 v35, v86, v87
    buffer_store_dwordx4 v[32:35], v16, s[24:27], s44 offen offset:0 sc1
    v_cvt_pk_bf16_f32 v36, v88, v89
    v_cvt_pk_bf16_f32 v37, v90, v91
    v_cvt_pk_bf16_f32 v38, v92, v93
    v_cvt_pk_bf16_f32 v39, v94, v95
    buffer_store_dwordx4 v[36:39], v16, s[24:27], s44 offen offset:640 sc1
    v_cvt_pk_bf16_f32 v40, v96, v97
    v_cvt_pk_bf16_f32 v41, v98, v99
    v_cvt_pk_bf16_f32 v42, v100, v101
    v_cvt_pk_bf16_f32 v43, v102, v103
    buffer_store_dwordx4 v[40:43], v16, s[24:27], s45 offen offset:0 sc1
    v_cvt_pk_bf16_f32 v44, v104, v105
    v_cvt_pk_bf16_f32 v45, v106, v107
    v_cvt_pk_bf16_f32 v46, v108, v109
    v_cvt_pk_bf16_f32 v47, v110, v111
    buffer_store_dwordx4 v[44:47], v16, s[24:27], s45 offen offset:640 sc1
    v_cvt_pk_bf16_f32 v48, v112, v113
    v_cvt_pk_bf16_f32 v49, v114, v115
    v_cvt_pk_bf16_f32 v50, v116, v117
    v_cvt_pk_bf16_f32 v51, v118, v119
    buffer_store_dwordx4 v[48:51], v17, s[24:27], s44 offen offset:0 sc1
    v_cvt_pk_bf16_f32 v52, v120, v121
    v_cvt_pk_bf16_f32 v53, v122, v123
    v_cvt_pk_bf16_f32 v54, v124, v125
    v_cvt_pk_bf16_f32 v55, v126, v127
    buffer_store_dwordx4 v[52:55], v17, s[24:27], s44 offen offset:640 sc1
    v_cvt_pk_bf16_f32 v56, v128, v129
    v_cvt_pk_bf16_f32 v57, v130, v131
    v_cvt_pk_bf16_f32 v58, v132, v133
    v_cvt_pk_bf16_f32 v59, v134, v135
    buffer_store_dwordx4 v[56:59], v17, s[24:27], s45 offen offset:0 sc1
    v_cvt_pk_bf16_f32 v60, v136, v137
    v_cvt_pk_bf16_f32 v61, v138, v139
    v_cvt_pk_bf16_f32 v62, v140, v141
    v_cvt_pk_bf16_f32 v63, v142, v143
    buffer_store_dwordx4 v[60:63], v17, s[24:27], s45 offen offset:640 sc1
    v_cvt_pk_bf16_f32 v32, v144, v145
    v_cvt_pk_bf16_f32 v33, v146, v147
    v_cvt_pk_bf16_f32 v34, v148, v149
    v_cvt_pk_bf16_f32 v35, v150, v151
    buffer_store_dwordx4 v[32:35], v18, s[24:27], s44 offen offset:0 sc1
    v_cvt_pk_bf16_f32 v36, v152, v153
    v_cvt_pk_bf16_f32 v37, v154, v155
    v_cvt_pk_bf16_f32 v38, v156, v157
    v_cvt_pk_bf16_f32 v39, v158, v159
    buffer_store_dwordx4 v[36:39], v18, s[24:27], s44 offen offset:640 sc1
    v_cvt_pk_bf16_f32 v40, v160, v161
    v_cvt_pk_bf16_f32 v41, v162, v163
    v_cvt_pk_bf16_f32 v42, v164, v165
    v_cvt_pk_bf16_f32 v43, v166, v167
    buffer_store_dwordx4 v[40:43], v18, s[24:27], s45 offen offset:0 sc1
    v_cvt_pk_bf16_f32 v44, v168, v169
    v_cvt_pk_bf16_f32 v45, v170, v171
    v_cvt_pk_bf16_f32 v46, v172, v173
    v_cvt_pk_bf16_f32 v47, v174, v175
    buffer_store_dwordx4 v[44:47], v18, s[24:27], s45 offen offset:640 sc1
    v_cvt_pk_bf16_f32 v48, v176, v177
    v_cvt_pk_bf16_f32 v49, v178, v179
    v_cvt_pk_bf16_f32 v50, v180, v181
    v_cvt_pk_bf16_f32 v51, v182, v183
    buffer_store_dwordx4 v[48:51], v19, s[24:27], s44 offen offset:0 sc1
    v_cvt_pk_bf16_f32 v52, v184, v185
    v_cvt_pk_bf16_f32 v53, v186, v187
    v_cvt_pk_bf16_f32 v54, v188, v189
    v_cvt_pk_bf16_f32 v55, v190, v191
    buffer_store_dwordx4 v[52:55], v19, s[24:27], s44 offen offset:640 sc1
    v_cvt_pk_bf16_f32 v56, v192, v193
    v_cvt_pk_bf16_f32 v57, v194, v195
    v_cvt_pk_bf16_f32 v58, v196, v197
    v_cvt_pk_bf16_f32 v59, v198, v199
    buffer_store_dwordx4 v[56:59], v19, s[24:27], s45 offen offset:0 sc1
    v_cvt_pk_bf16_f32 v60, v200, v201
    v_cvt_pk_bf16_f32 v61, v202, v203
    v_cvt_pk_bf16_f32 v62, v204, v205
    v_cvt_pk_bf16_f32 v63, v206, v207
    buffer_store_dwordx4 v[60:63], v19, s[24:27], s45 offen offset:640 sc1
K1_DONE:
    v_mbcnt_lo_u32_b32 v0, -1, 0
    v_mbcnt_hi_u32_b32 v0, -1, v0
    s_lshl_b32 s3, s90, 6
    v_add_u32 v0, s3, v0
    s_cmp_ge_u32 s2, 0x100
    s_cbranch_scc1 K2_END
    s_load_dwordx2 s[4:5], s[0:1], 40
    s_load_dwordx4 s[8:11], s[0:1], 64
    v_mov_b32 v6, 58368
    v_mov_b32 v8, 0
    v_mov_b32 v9, 0
    v_mov_b32 v10, 0
    v_mov_b32 v11, 0
    ds_write_b128 v6, v[8:11]
    ds_write_b128 v6, v[8:11] offset:16
    s_and_b32 s3, s2, 7
    s_lshr_b32 s14, s2, 6
    s_lshl_b32 s14, s14, 3
    s_add_u32 s28, s14, s3
    s_bfe_u32 s29, s2, 0x30003
    v_lshrrev_b32 v1, 6, v0
    v_and_b32 v0, 63, v0
    v_readfirstlane_b32 s33, v1
    v_and_b32 v1, 31, v0
    v_lshrrev_b32 v2, 5, v0
    s_and_b32 s30, s28, 1
    s_lshl_b32 s31, s30, 10
    v_lshlrev_b32 v6, 4, v0
    v_add_u32 v3, s31, v6
    s_lshl_b32 s31, s30, 3
    s_add_u32 s31, s31, 0x800
    v_lshlrev_b32 v4, 4, v1
    v_add_u32 v4, s31, v4
    s_mul_i32 s31, s30, 0x500
    s_add_u32 s31, s31, 0xa00
    v_mul_u32_u24 v5, 0x140, v2
    v_lshl_add_u32 v5, v1, 4, v5
    v_add_u32 v5, s31, v5
    s_mov_b32 s60, -1
    s_mov_b32 s61, 0
    s_mov_b32 s62, 0xfffff
    s_mov_b32 s63, 0xfffff
    s_mov_b32 s64, 0
    s_mov_b32 s65, -1
    s_lshr_b32 s34, s33, 2
    s_and_b32 s35, s33, 3
    s_lshr_b32 s36, s28, 1
    s_lshl_b32 s36, s36, 6
    s_lshl_b32 s37, s29, 3
    s_lshl_b32 s42, s35, 1
    s_add_u32 s42, s42, s37
    s_add_u32 s39, s36, s42
    s_mul_i32 s44, s39, 0xa00
    s_add_u32 s45, s44, 0xa00
    s_add_u32 s39, s39, 0x400
    s_mul_i32 s40, s39, 0xa00
    s_add_u32 s41, s40, 0xa00
    s_mul_i32 s39, s39, 5120
    s_add_u32 s39, s39, 5242880
    s_add_u32 s38, s39, 5120
    s_cmp_eq_u32 s34, 0
    s_cselect_b32 s40, s40, s39
    s_cselect_b32 s41, s41, s38
    s_mul_i32 s46, s36, 5120
    s_add_u32 s46, s46, 5242880
    s_mul_i32 s47, s34, 163840
    s_add_u32 s66, s47, s46
    s_add_u32 s67, s66, 163840
    s_mul_i32 s47, s29, 0
    s_add_u32 s47, s47, s66
    v_and_b32 v7, 3, v1
    v_lshrrev_b32 v8, 3, v1
    v_lshl_add_u32 v7, v8, 2, v7
    v_cmp_gt_u32 vcc, 10, v7
    v_bfe_u32 v8, v1, 2, 1
    v_mad_u32_u24 v7, v8, 10, v7
    v_lshlrev_b32 v7, 1, v7
    s_mul_i32 s48, s28, 800
    v_add_u32 v7, s48, v7
    v_mov_b32 v8, 0x100000
    v_cndmask_b32 v7, v8, v7, vcc
    s_mul_i32 s48, s30, 160
    v_mul_u32_u24 v10, 0x140, v2
    v_add3_u32 v10, v10, v7, s48
    s_mul_i32 s48, s30, 640
    s_sub_u32 s48, 640, s48
    v_add_u32 v7, s48, v7
    v_cmp_eq_u32 vcc, 20, v1
    v_cmp_eq_u32 s[50:51], 24, v1
    s_nop 0
    s_or_b64 vcc, vcc, s[50:51]
    v_mov_b32 v8, 0x3f803f80
    v_cndmask_b32 v9, 0, v8, vcc
    v_mov_b32 v114, v9
    v_mov_b32 v115, v9
    v_mov_b32 v116, v9
    v_mov_b32 v117, v9
    v_mov_b32 v118, v9
    v_mov_b32 v119, v9
    v_mov_b32 v120, v9
    v_mov_b32 v121, v9
    v_mov_b32 v112, v8
    v_mov_b32 v113, 0
    v_mov_b32 v128, v9
    v_mov_b32 v129, v9
    v_mov_b32 v130, v9
    v_mov_b32 v131, v9
    v_mov_b32 v132, v9
    v_mov_b32 v133, v9
    v_mov_b32 v134, v9
    v_mov_b32 v135, v9
    v_mov_b32 v126, v8
    v_mov_b32 v127, 0
    v_mov_b32 v142, v9
    v_mov_b32 v143, v9
    v_mov_b32 v144, v9
    v_mov_b32 v145, v9
    v_mov_b32 v146, v9
    v_mov_b32 v147, v9
    v_mov_b32 v148, v9
    v_mov_b32 v149, v9
    v_mov_b32 v140, v8
    v_mov_b32 v141, 0
    v_mov_b32 v156, v9
    v_mov_b32 v157, v9
    v_mov_b32 v158, v9
    v_mov_b32 v159, v9
    v_mov_b32 v160, v9
    v_mov_b32 v161, v9
    v_mov_b32 v162, v9
    v_mov_b32 v163, v9
    v_mov_b32 v154, v8
    v_mov_b32 v155, 0
    v_mov_b32 v174, 0
    v_mov_b32 v175, 0
    v_mov_b32 v180, 0
    v_mov_b32 v181, 0
    v_mov_b32 v186, 0
    v_mov_b32 v187, 0
    v_mov_b32 v100, 0
    v_mov_b32 v101, 0
    v_mov_b32 v106, 0
    v_mov_b32 v107, 0
    v_mov_b32 v168, v8
    v_mov_b32 v169, 0
    s_waitcnt lgkmcnt(0)
    s_mov_b32 s16, s4
    s_mov_b32 s17, s5
    s_mov_b32 s18, 25600
    s_mov_b32 s19, 0x20000
    s_mov_b32 s20, s10
    s_mov_b32 s21, s11
    s_mov_b32 s22, 24117248
    s_mov_b32 s23, 0x20000
    s_mov_b32 s24, s8
    s_mov_b32 s25, s9
    s_mov_b32 s26, 256
    s_mov_b32 s27, 0x20000
    buffer_load_ushort v188, v10, s[16:19], 0 offen offset:0
    buffer_load_ushort v189, v10, s[16:19], 0 offen offset:40
    buffer_load_ushort v190, v10, s[16:19], 0 offen offset:80
    buffer_load_ushort v191, v10, s[16:19], 0 offen offset:120
    buffer_load_ushort v192, v10, s[16:19], 0 offen offset:160
    buffer_load_ushort v193, v10, s[16:19], 0 offen offset:200
    buffer_load_ushort v194, v10, s[16:19], 0 offen offset:240
    buffer_load_ushort v195, v10, s[16:19], 0 offen offset:280
    s_mov_b64 exec, s[60:61]
    buffer_load_ushort v196, v7, s[16:19], 0 offen offset:0
    buffer_load_ushort v197, v7, s[16:19], 0 offen offset:40
    buffer_load_ushort v198, v7, s[16:19], 0 offen offset:80
    buffer_load_ushort v199, v7, s[16:19], 0 offen offset:120
    s_mov_b64 exec, -1
    s_waitcnt vmcnt(0)
    v_lshl_or_b32 v164, v189, 16, v188
    v_lshl_or_b32 v165, v191, 16, v190
    v_lshl_or_b32 v166, v193, 16, v192
    v_lshl_or_b32 v167, v195, 16, v194
    s_mov_b64 exec, s[60:61]
    v_lshl_or_b32 v168, v197, 16, v196
    v_lshl_or_b32 v169, v199, 16, v198
    s_mov_b64 exec, -1
    v_xor_b32 v228, 0x80008000, v164
    v_xor_b32 v229, 0x80008000, v165
    v_xor_b32 v230, 0x80008000, v166
    v_xor_b32 v231, 0x80008000, v167
    v_xor_b32 v232, 0x80008000, v168
    v_xor_b32 v233, 0x80008000, v169
    v_cndmask_b32 v232, v232, 0, s[64:65]
    v_cndmask_b32 v233, v233, v8, s[64:65]
    v_mov_b32 v234, v9
    v_mov_b32 v235, v9
    v_mov_b32 v236, v9
    v_mov_b32 v237, v9
    v_mov_b32 v238, v9
    v_mov_b32 v239, v9
    v_mov_b32 v240, v9
    v_mov_b32 v241, v9
    v_mov_b32 v242, v9
    v_mov_b32 v243, v9
    v_mov_b32 v244, v9
    v_mov_b32 v245, v9
    v_mov_b32 v246, v9
    v_mov_b32 v247, v9
    v_mov_b32 v248, v9
    v_mov_b32 v249, v9
    s_waitcnt vmcnt(0)
    v_mov_b32 v14, 163836
    s_cmp_lg_u32 s90, 0
    s_cbranch_scc1 K1_D1
    v_readfirstlane_b32 s48, v210
    s_nop 0
    s_cmp_eq_u32 s48, 0
    s_cselect_b32 s91, s91, s48
    v_mov_b32 v16, s91
    ds_write_b32 v14, v16
    s_lshl_b32 s48, s2, 2
    s_add_u32 s48, s48, 22544384
    v_lshl_add_u32 v17, v0, 10, s48
    s_and_b32 s48, s2, 31
    s_lshl_b32 s48, s48, 10
    s_add_u32 s48, s48, 22544384
    v_add_u32 v15, s48, v6
    s_waitcnt lgkmcnt(0)
    s_barrier
    s_mov_b64 exec, s[60:61]
    buffer_store_dword v16, v17, s[96:99], 0 offen sc1
    s_mov_b64 exec, -1
    s_mov_b32 s89, 0
K2_Q1:
    buffer_load_dwordx4 v[20:23], v15, s[96:99], 0 offen sc1
    s_add_u32 s89, s89, 1
    s_waitcnt vmcnt(0)
    v_xor_b32 v20, s91, v20
    v_xor_b32 v21, s91, v21
    v_xor_b32 v22, s91, v22
    v_xor_b32 v23, s91, v23
    v_or3_b32 v20, v20, v21, v22
    v_or_b32 v20, v20, v23
    v_cmp_ne_u32 vcc, 0, v20
    s_cbranch_vccz K2_Q1X
    s_sleep 2
    s_cmp_lt_u32 s89, 0x8000
    s_cbranch_scc1 K2_Q1
K2_Q1X:
    s_branch K1_D2
K1_D1:
    s_waitcnt lgkmcnt(0)
    s_barrier
    ds_read_b32 v16, v14
    s_waitcnt lgkmcnt(0)
    v_readfirstlane_b32 s91, v16
K1_D2:
    s_lshl_b32 s52, s28, 2
    s_add_u32 s52, s52, 64
    s_barrier
    s_cmp_eq_u32 s34, 0
    s_cbranch_scc0 K2_BW
    s_setprio 2
    s_mov_b64 exec, s[60:61]
    buffer_load_dwordx2 v[186:187], v4, s[20:23], s46 offen
    buffer_load_dwordx2 v[100:101], v4, s[20:23], s44 offen
    buffer_load_dwordx2 v[106:107], v4, s[20:23], s45 offen
    s_mov_b64 exec, -1
    buffer_load_dwordx4 v[182:185], v3, s[20:23], s46 offen
    buffer_load_dwordx4 v[96:99], v3, s[20:23], s44 offen
    buffer_load_dwordx4 v[102:105], v3, s[20:23], s45 offen
    s_mov_b64 exec, s[60:61]
    buffer_load_dwordx2 v[112:113], v4, s[20:23], s47 offen
    s_mov_b64 exec, s[62:63]
    buffer_load_dwordx4 v[114:117], v5, s[20:23], s47 offen
    buffer_load_dwordx4 v[118:121], v5, s[20:23], s47 offen offset:640
    s_mov_b64 exec, -1
    buffer_load_dwordx4 v[108:111], v3, s[20:23], s47 offen
    s_add_u32 s47, s47, 5120
    s_cmp_eq_u32 s47, s67
    s_cselect_b32 s47, s66, s47
    s_waitcnt vmcnt(4)
    s_mov_b64 exec, s[60:61]
    buffer_load_dwordx2 v[126:127], v4, s[20:23], s47 offen
    s_mov_b64 exec, s[62:63]
    buffer_load_dwordx4 v[128:131], v5, s[20:23], s47 offen
    buffer_load_dwordx4 v[132:135], v5, s[20:23], s47 offen offset:640
    s_mov_b64 exec, -1
    buffer_load_dwordx4 v[122:125], v3, s[20:23], s47 offen
    s_add_u32 s47, s47, 5120
    s_cmp_eq_u32 s47, s67
    s_cselect_b32 s47, s66, s47
    s_mov_b64 exec, s[60:61]
    buffer_load_dwordx2 v[140:141], v4, s[20:23], s47 offen
    s_mov_b64 exec, s[62:63]
    buffer_load_dwordx4 v[142:145], v5, s[20:23], s47 offen
    buffer_load_dwordx4 v[146:149], v5, s[20:23], s47 offen offset:640
    s_mov_b64 exec, -1
    buffer_load_dwordx4 v[136:139], v3, s[20:23], s47 offen
    s_add_u32 s47, s47, 5120
    s_cmp_eq_u32 s47, s67
    s_cselect_b32 s47, s66, s47
    v_mfma_f32_32x32x16_bf16 v[48:63], v[182:185], v[96:99], 0
    v_mfma_f32_32x32x8bf16_1k v[48:63], v[186:187], v[100:101], v[48:63]
    v_mfma_f32_32x32x16_bf16 v[64:79], v[182:185], v[102:105], 0
    v_mfma_f32_32x32x8bf16_1k v[64:79], v[186:187], v[106:107], v[64:79]
    s_nop 9
    v_max3_f32 v10, v48, v49, v50
    v_max3_f32 v10, v10, v51, v52
    v_max3_f32 v10, v10, v53, v54
    v_max3_f32 v10, v10, v55, v56
    v_max3_f32 v10, v10, v57, v58
    v_max3_f32 v10, v10, v59, v60
    v_max3_f32 v10, v10, v61, v62
    v_max_f32 v10, v10, v63
    v_mov_b32 v14, v10
    s_nop 1
    v_permlane32_swap_b32 v14, v10
    v_max_f32 v10, v10, v14
    v_sub_f32 v10, 0, v10
    v_and_b32 v14, 0xffff0000, v10
    v_sub_f32 v15, v10, v14
    v_cvt_pk_bf16_f32 v14, v14, v15
    v_cndmask_b32 v100, v100, v14, s[64:65]
    v_max3_f32 v10, v64, v65, v66
    v_max3_f32 v10, v10, v67, v68
    v_max3_f32 v10, v10, v69, v70
    v_max3_f32 v10, v10, v71, v72
    v_max3_f32 v10, v10, v73, v74
    v_max3_f32 v10, v10, v75, v76
    v_max3_f32 v10, v10, v77, v78
    v_max_f32 v10, v10, v79
    v_mov_b32 v14, v10
    s_nop 1
    v_permlane32_swap_b32 v14, v10
    v_max_f32 v10, v10, v14
    v_sub_f32 v10, 0, v10
    v_and_b32 v14, 0xffff0000, v10
    v_sub_f32 v15, v10, v14
    v_cvt_pk_bf16_f32 v14, v14, v15
    v_cndmask_b32 v106, v106, v14, s[64:65]
    s_mov_b64 exec, s[60:61]
    buffer_load_dwordx2 v[174:175], v4, s[20:23], s40 offen
    buffer_load_dwordx2 v[180:181], v4, s[20:23], s41 offen
    s_mov_b64 exec, -1
    buffer_load_dwordx4 v[170:173], v3, s[20:23], s40 offen
    buffer_load_dwordx4 v[176:179], v3, s[20:23], s41 offen
    s_waitcnt vmcnt(12)
    s_branch K2_GO
K2_BW:
    s_setprio 3
    s_mov_b64 exec, s[60:61]
    buffer_load_dwordx2 v[174:175], v4, s[20:23], s40 offen
    buffer_load_dwordx2 v[180:181], v4, s[20:23], s41 offen
    s_mov_b64 exec, -1
    buffer_load_dwordx4 v[170:173], v3, s[20:23], s40 offen
    buffer_load_dwordx4 v[176:179], v3, s[20:23], s41 offen
    s_waitcnt vmcnt(0)
    s_mov_b64 exec, s[62:63]
    buffer_load_dwordx4 v[234:237], v5, s[20:23], s40 offen
    buffer_load_dwordx4 v[238:241], v5, s[20:23], s40 offen offset:640
    buffer_load_dwordx4 v[242:245], v5, s[20:23], s41 offen
    buffer_load_dwordx4 v[246:249], v5, s[20:23], s41 offen offset:640
    s_mov_b64 exec, -1
    v_mfma_f32_32x32x16_bf16 v[16:31], v[164:167], v[170:173], 0
    v_mfma_f32_32x32x8bf16_1k v[16:31], v[168:169], v[174:175], v[16:31]
    s_nop 11
    v_max3_f32 v10, v16, v17, v18
    v_max3_f32 v10, v10, v19, v20
    v_max3_f32 v10, v10, v21, v22
    v_max3_f32 v10, v10, v23, v24
    v_max_f32 v10, v10, v25
    v_min3_f32 v11, v16, v17, v18
    v_min3_f32 v11, v11, v19, v20
    v_min3_f32 v11, v11, v21, v22
    v_min3_f32 v11, v11, v23, v24
    v_min_f32 v11, v11, v25
    v_mov_b32 v14, v10
    s_nop 1
    v_permlane32_swap_b32 v14, v10
    v_max_f32 v10, v10, v14
    v_mov_b32 v15, v11
    s_nop 1
    v_permlane32_swap_b32 v15, v11
    v_min_f32 v11, v11, v15
    v_sub_f32 v32, v11, v16
    v_sub_f32 v33, v11, v17
    v_sub_f32 v34, v11, v18
    v_sub_f32 v35, v11, v19
    v_sub_f32 v36, v11, v20
    v_sub_f32 v37, v11, v21
    v_sub_f32 v38, v11, v22
    v_sub_f32 v39, v11, v23
    v_sub_f32 v40, v11, v24
    v_sub_f32 v41, v11, v25
    v_sub_f32 v16, v16, v10
    v_sub_f32 v17, v17, v10
    v_sub_f32 v18, v18, v10
    v_sub_f32 v19, v19, v10
    v_sub_f32 v20, v20, v10
    v_sub_f32 v21, v21, v10
    v_sub_f32 v22, v22, v10
    v_sub_f32 v23, v23, v10
    v_sub_f32 v24, v24, v10
    v_sub_f32 v25, v25, v10
    v_exp_f32 v32, v32
    v_exp_f32 v33, v33
    v_exp_f32 v34, v34
    v_exp_f32 v35, v35
    v_exp_f32 v36, v36
    v_exp_f32 v37, v37
    v_exp_f32 v38, v38
    v_exp_f32 v39, v39
    v_exp_f32 v40, v40
    v_exp_f32 v41, v41
    v_exp_f32 v16, v16
    v_exp_f32 v17, v17
    v_exp_f32 v18, v18
    v_exp_f32 v19, v19
    v_exp_f32 v20, v20
    v_exp_f32 v21, v21
    v_exp_f32 v22, v22
    v_exp_f32 v23, v23
    v_exp_f32 v24, v24
    v_exp_f32 v25, v25
    v_pk_add_f32 v[14:15], v[32:33], v[34:35]
    v_pk_add_f32 v[14:15], v[14:15], v[36:37]
    v_pk_add_f32 v[14:15], v[14:15], v[38:39]
    v_pk_add_f32 v[14:15], v[14:15], v[40:41]
    v_add_f32 v13, v14, v15
    v_pk_add_f32 v[14:15], v[16:17], v[18:19]
    v_pk_add_f32 v[14:15], v[14:15], v[20:21]
    v_pk_add_f32 v[14:15], v[14:15], v[22:23]
    v_pk_add_f32 v[14:15], v[14:15], v[24:25]
    v_add_f32 v12, v14, v15
    v_mov_b32 v14, v12
    s_nop 1
    v_permlane32_swap_b32 v14, v12
    v_add_f32 v12, v12, v14
    v_mov_b32 v15, v13
    s_nop 1
    v_permlane32_swap_b32 v15, v13
    v_add_f32 v13, v13, v15
    v_log_f32 v12, v12
    v_log_f32 v13, v13
    v_sub_f32 v10, 0, v10
    v_sub_f32 v12, v10, v12
    v_sub_f32 v13, v11, v13
    v_and_b32 v14, 0xffff0000, v12
    v_sub_f32 v15, v12, v14
    v_cvt_pk_bf16_f32 v14, v14, v15
    v_cndmask_b32 v174, v174, v14, s[64:65]
    v_and_b32 v14, 0xffff0000, v13
    v_sub_f32 v15, v13, v14
    v_cvt_pk_bf16_f32 v14, v14, v15
    v_cndmask_b32 v175, v175, v14, s[64:65]
    v_mfma_f32_32x32x16_bf16 v[16:31], v[170:173], v[164:167], 0
    s_nop 0
    v_mfma_f32_32x32x8bf16_1k v[16:31], v[174:175], v[168:169], v[16:31]
    v_mfma_f32_32x32x16_bf16 v[32:47], v[170:173], v[228:231], 0
    v_mfma_f32_32x32x8bf16_1k v[32:47], v[174:175], v[232:233], v[32:47]
    s_mov_b64 exec, s[60:61]
    buffer_load_dwordx2 v[186:187], v4, s[20:23], s46 offen
    buffer_load_dwordx2 v[100:101], v4, s[20:23], s44 offen
    buffer_load_dwordx2 v[106:107], v4, s[20:23], s45 offen
    s_mov_b64 exec, -1
    buffer_load_dwordx4 v[182:185], v3, s[20:23], s46 offen
    buffer_load_dwordx4 v[96:99], v3, s[20:23], s44 offen
    buffer_load_dwordx4 v[102:105], v3, s[20:23], s45 offen
    s_mov_b64 exec, s[60:61]
    buffer_load_dwordx2 v[112:113], v4, s[20:23], s47 offen
    s_mov_b64 exec, s[62:63]
    buffer_load_dwordx4 v[114:117], v5, s[20:23], s47 offen
    buffer_load_dwordx4 v[118:121], v5, s[20:23], s47 offen offset:640
    s_mov_b64 exec, -1
    buffer_load_dwordx4 v[108:111], v3, s[20:23], s47 offen
    s_add_u32 s47, s47, 5120
    s_cmp_eq_u32 s47, s67
    s_cselect_b32 s47, s66, s47
    s_mov_b64 exec, s[60:61]
    buffer_load_dwordx2 v[126:127], v4, s[20:23], s47 offen
    s_mov_b64 exec, s[62:63]
    buffer_load_dwordx4 v[128:131], v5, s[20:23], s47 offen
    buffer_load_dwordx4 v[132:135], v5, s[20:23], s47 offen offset:640
    s_mov_b64 exec, -1
    buffer_load_dwordx4 v[122:125], v3, s[20:23], s47 offen
    s_add_u32 s47, s47, 5120
    s_cmp_eq_u32 s47, s67
    s_cselect_b32 s47, s66, s47
    s_mov_b64 exec, s[60:61]
    buffer_load_dwordx2 v[140:141], v4, s[20:23], s47 offen
    s_mov_b64 exec, s[62:63]
    buffer_load_dwordx4 v[142:145], v5, s[20:23], s47 offen
    buffer_load_dwordx4 v[146:149], v5, s[20:23], s47 offen offset:640
    s_mov_b64 exec, -1
    buffer_load_dwordx4 v[136:139], v3, s[20:23], s47 offen
    s_add_u32 s47, s47, 5120
    s_cmp_eq_u32 s47, s67
    s_cselect_b32 s47, s66, s47
    s_waitcnt vmcnt(18)
    v_exp_f32 v16, v16
    v_exp_f32 v17, v17
    v_exp_f32 v18, v18
    v_exp_f32 v19, v19
    v_exp_f32 v20, v20
    v_exp_f32 v21, v21
    v_exp_f32 v22, v22
    v_exp_f32 v23, v23
    v_exp_f32 v24, v24
    v_exp_f32 v25, v25
    v_exp_f32 v26, v26
    v_exp_f32 v27, v27
    v_exp_f32 v28, v28
    v_exp_f32 v29, v29
    v_exp_f32 v30, v30
    v_exp_f32 v31, v31
    v_cvt_pk_bf16_f32 v80, v16, v17
    v_cvt_pk_bf16_f32 v81, v18, v19
    v_cvt_pk_bf16_f32 v82, v20, v21
    v_cvt_pk_bf16_f32 v83, v22, v23
    v_cvt_pk_bf16_f32 v84, v24, v25
    v_cvt_pk_bf16_f32 v85, v26, v27
    v_cvt_pk_bf16_f32 v86, v28, v29
    v_cvt_pk_bf16_f32 v87, v30, v31
    v_mfma_f32_32x32x16_bf16 v[48:63], v[80:83], v[234:237], 0
    s_nop 0
    v_mfma_f32_32x32x16_bf16 v[48:63], v[84:87], v[238:241], v[48:63]
    v_exp_f32 v32, v32
    v_exp_f32 v33, v33
    v_exp_f32 v34, v34
    v_exp_f32 v35, v35
    v_exp_f32 v36, v36
    v_exp_f32 v37, v37
    v_exp_f32 v38, v38
    v_exp_f32 v39, v39
    v_exp_f32 v40, v40
    v_exp_f32 v41, v41
    v_exp_f32 v42, v42
    v_exp_f32 v43, v43
    v_exp_f32 v44, v44
    v_exp_f32 v45, v45
    v_exp_f32 v46, v46
    v_exp_f32 v47, v47
    v_cvt_pk_bf16_f32 v88, v32, v33
    v_cvt_pk_bf16_f32 v89, v34, v35
    v_cvt_pk_bf16_f32 v90, v36, v37
    v_cvt_pk_bf16_f32 v91, v38, v39
    v_cvt_pk_bf16_f32 v92, v40, v41
    v_cvt_pk_bf16_f32 v93, v42, v43
    v_cvt_pk_bf16_f32 v94, v44, v45
    v_cvt_pk_bf16_f32 v95, v46, v47
    v_mfma_f32_32x32x16_bf16 v[64:79], v[88:91], v[234:237], 0
    s_nop 0
    v_mfma_f32_32x32x16_bf16 v[64:79], v[92:95], v[238:241], v[64:79]
    v_mfma_f32_32x32x16_bf16 v[16:31], v[164:167], v[176:179], 0
    v_mfma_f32_32x32x8bf16_1k v[16:31], v[168:169], v[180:181], v[16:31]
    s_nop 11
    v_max3_f32 v10, v16, v17, v18
    v_max3_f32 v10, v10, v19, v20
    v_max3_f32 v10, v10, v21, v22
    v_max3_f32 v10, v10, v23, v24
    v_max_f32 v10, v10, v25
    v_min3_f32 v11, v16, v17, v18
    v_min3_f32 v11, v11, v19, v20
    v_min3_f32 v11, v11, v21, v22
    v_min3_f32 v11, v11, v23, v24
    v_min_f32 v11, v11, v25
    v_mov_b32 v14, v10
    s_nop 1
    v_permlane32_swap_b32 v14, v10
    v_max_f32 v10, v10, v14
    v_mov_b32 v15, v11
    s_nop 1
    v_permlane32_swap_b32 v15, v11
    v_min_f32 v11, v11, v15
    v_sub_f32 v32, v11, v16
    v_sub_f32 v33, v11, v17
    v_sub_f32 v34, v11, v18
    v_sub_f32 v35, v11, v19
    v_sub_f32 v36, v11, v20
    v_sub_f32 v37, v11, v21
    v_sub_f32 v38, v11, v22
    v_sub_f32 v39, v11, v23
    v_sub_f32 v40, v11, v24
    v_sub_f32 v41, v11, v25
    v_sub_f32 v16, v16, v10
    v_sub_f32 v17, v17, v10
    v_sub_f32 v18, v18, v10
    v_sub_f32 v19, v19, v10
    v_sub_f32 v20, v20, v10
    v_sub_f32 v21, v21, v10
    v_sub_f32 v22, v22, v10
    v_sub_f32 v23, v23, v10
    v_sub_f32 v24, v24, v10
    v_sub_f32 v25, v25, v10
    v_exp_f32 v32, v32
    v_exp_f32 v33, v33
    v_exp_f32 v34, v34
    v_exp_f32 v35, v35
    v_exp_f32 v36, v36
    v_exp_f32 v37, v37
    v_exp_f32 v38, v38
    v_exp_f32 v39, v39
    v_exp_f32 v40, v40
    v_exp_f32 v41, v41
    v_exp_f32 v16, v16
    v_exp_f32 v17, v17
    v_exp_f32 v18, v18
    v_exp_f32 v19, v19
    v_exp_f32 v20, v20
    v_exp_f32 v21, v21
    v_exp_f32 v22, v22
    v_exp_f32 v23, v23
    v_exp_f32 v24, v24
    v_exp_f32 v25, v25
    v_pk_add_f32 v[14:15], v[32:33], v[34:35]
    v_pk_add_f32 v[14:15], v[14:15], v[36:37]
    v_pk_add_f32 v[14:15], v[14:15], v[38:39]
    v_pk_add_f32 v[14:15], v[14:15], v[40:41]
    v_add_f32 v13, v14, v15
    v_pk_add_f32 v[14:15], v[16:17], v[18:19]
    v_pk_add_f32 v[14:15], v[14:15], v[20:21]
    v_pk_add_f32 v[14:15], v[14:15], v[22:23]
    v_pk_add_f32 v[14:15], v[14:15], v[24:25]
    v_add_f32 v12, v14, v15
    v_mov_b32 v14, v12
    s_nop 1
    v_permlane32_swap_b32 v14, v12
    v_add_f32 v12, v12, v14
    v_mov_b32 v15, v13
    s_nop 1
    v_permlane32_swap_b32 v15, v13
    v_add_f32 v13, v13, v15
    v_log_f32 v12, v12
    v_log_f32 v13, v13
    v_sub_f32 v10, 0, v10
    v_sub_f32 v12, v10, v12
    v_sub_f32 v13, v11, v13
    v_and_b32 v14, 0xffff0000, v12
    v_sub_f32 v15, v12, v14
    v_cvt_pk_bf16_f32 v14, v14, v15
    v_cndmask_b32 v180, v180, v14, s[64:65]
    v_and_b32 v14, 0xffff0000, v13
    v_sub_f32 v15, v13, v14
    v_cvt_pk_bf16_f32 v14, v14, v15
    v_cndmask_b32 v181, v181, v14, s[64:65]
    v_mfma_f32_32x32x16_bf16 v[16:31], v[176:179], v[164:167], 0
    s_nop 0
    v_mfma_f32_32x32x8bf16_1k v[16:31], v[180:181], v[168:169], v[16:31]
    v_mfma_f32_32x32x16_bf16 v[32:47], v[176:179], v[228:231], 0
    v_mfma_f32_32x32x8bf16_1k v[32:47], v[180:181], v[232:233], v[32:47]
    s_nop 9
    v_exp_f32 v16, v16
    v_exp_f32 v17, v17
    v_exp_f32 v18, v18
    v_exp_f32 v19, v19
    v_exp_f32 v20, v20
    v_exp_f32 v21, v21
    v_exp_f32 v22, v22
    v_exp_f32 v23, v23
    v_exp_f32 v24, v24
    v_exp_f32 v25, v25
    v_exp_f32 v26, v26
    v_exp_f32 v27, v27
    v_exp_f32 v28, v28
    v_exp_f32 v29, v29
    v_exp_f32 v30, v30
    v_exp_f32 v31, v31
    v_cvt_pk_bf16_f32 v80, v16, v17
    v_cvt_pk_bf16_f32 v81, v18, v19
    v_cvt_pk_bf16_f32 v82, v20, v21
    v_cvt_pk_bf16_f32 v83, v22, v23
    v_cvt_pk_bf16_f32 v84, v24, v25
    v_cvt_pk_bf16_f32 v85, v26, v27
    v_cvt_pk_bf16_f32 v86, v28, v29
    v_cvt_pk_bf16_f32 v87, v30, v31
    v_mfma_f32_32x32x16_bf16 v[48:63], v[80:83], v[242:245], v[48:63]
    s_nop 0
    v_mfma_f32_32x32x16_bf16 v[48:63], v[84:87], v[246:249], v[48:63]
    v_exp_f32 v32, v32
    v_exp_f32 v33, v33
    v_exp_f32 v34, v34
    v_exp_f32 v35, v35
    v_exp_f32 v36, v36
    v_exp_f32 v37, v37
    v_exp_f32 v38, v38
    v_exp_f32 v39, v39
    v_exp_f32 v40, v40
    v_exp_f32 v41, v41
    v_exp_f32 v42, v42
    v_exp_f32 v43, v43
    v_exp_f32 v44, v44
    v_exp_f32 v45, v45
    v_exp_f32 v46, v46
    v_exp_f32 v47, v47
    v_cvt_pk_bf16_f32 v88, v32, v33
    v_cvt_pk_bf16_f32 v89, v34, v35
    v_cvt_pk_bf16_f32 v90, v36, v37
    v_cvt_pk_bf16_f32 v91, v38, v39
    v_cvt_pk_bf16_f32 v92, v40, v41
    v_cvt_pk_bf16_f32 v93, v42, v43
    v_cvt_pk_bf16_f32 v94, v44, v45
    v_cvt_pk_bf16_f32 v95, v46, v47
    v_mfma_f32_32x32x16_bf16 v[64:79], v[88:91], v[242:245], v[64:79]
    s_nop 0
    v_mfma_f32_32x32x16_bf16 v[64:79], v[92:95], v[246:249], v[64:79]
    s_mul_i32 s48, s35, 0x1400
    s_add_u32 s48, s48, 32768
    v_add_u32 v10, s48, v6
    v_mov_b32 v11, 58368
    v_mov_b32 v12, 1
    s_nop 6
    v_mov_b32 v58, v72
    v_mov_b32 v59, v73
    ds_write_b128 v10, v[48:51] offset:0
    ds_write_b128 v10, v[52:55] offset:1024
    ds_write_b128 v10, v[64:67] offset:2048
    ds_write_b128 v10, v[68:71] offset:3072
    ds_write_b128 v10, v[56:59] offset:4096
    s_waitcnt lgkmcnt(0)
    s_mov_b64 exec, 1
    ds_add_rtn_u32 v12, v11, v12
    s_mov_b64 exec, -1
    s_waitcnt lgkmcnt(0)
    v_readfirstlane_b32 s48, v12
    s_nop 0
    s_cmp_eq_u32 s48, 3
    s_cbranch_scc0 K2_NL
    s_lshl_b32 s48, s28, 3
    s_add_u32 s48, s48, s29
    s_mul_i32 s48, s48, 0x1400
    s_add_u32 s48, s48, 20971520
    s_add_u32 s49, s48, 0x1000
    ds_read_b128 v[16:19], v6 offset:32768
    ds_read_b128 v[20:23], v6 offset:37888
    ds_read_b128 v[24:27], v6 offset:43008
    ds_read_b128 v[28:31], v6 offset:48128
    ds_read_b128 v[32:35], v6 offset:33792
    ds_read_b128 v[36:39], v6 offset:38912
    ds_read_b128 v[40:43], v6 offset:44032
    ds_read_b128 v[44:47], v6 offset:49152
    ds_read_b128 v[48:51], v6 offset:34816
    ds_read_b128 v[52:55], v6 offset:39936
    ds_read_b128 v[56:59], v6 offset:45056
    ds_read_b128 v[60:63], v6 offset:50176
    ds_read_b128 v[64:67], v6 offset:35840
    ds_read_b128 v[68:71], v6 offset:40960
    ds_read_b128 v[72:75], v6 offset:46080
    ds_read_b128 v[76:79], v6 offset:51200
    ds_read_b128 v[80:83], v6 offset:36864
    ds_read_b128 v[84:87], v6 offset:41984
    ds_read_b128 v[88:91], v6 offset:47104
    ds_read_b128 v[92:95], v6 offset:52224
    s_waitcnt lgkmcnt(15)
    v_pk_add_f32 v[16:17], v[16:17], v[24:25]
    v_pk_add_f32 v[18:19], v[18:19], v[26:27]
    v_pk_add_f32 v[20:21], v[20:21], v[28:29]
    v_pk_add_f32 v[22:23], v[22:23], v[30:31]
    v_pk_add_f32 v[16:17], v[16:17], v[20:21]
    v_pk_add_f32 v[18:19], v[18:19], v[22:23]
    buffer_store_dwordx4 v[16:19], v6, s[20:23], s48 offen offset:0 sc1
    s_waitcnt lgkmcnt(12)
    v_pk_add_f32 v[32:33], v[32:33], v[40:41]
    v_pk_add_f32 v[34:35], v[34:35], v[42:43]
    v_pk_add_f32 v[36:37], v[36:37], v[44:45]
    v_pk_add_f32 v[38:39], v[38:39], v[46:47]
    v_pk_add_f32 v[32:33], v[32:33], v[36:37]
    v_pk_add_f32 v[34:35], v[34:35], v[38:39]
    buffer_store_dwordx4 v[32:35], v6, s[20:23], s48 offen offset:1024 sc1
    s_waitcnt lgkmcnt(8)
    v_pk_add_f32 v[48:49], v[48:49], v[56:57]
    v_pk_add_f32 v[50:51], v[50:51], v[58:59]
    v_pk_add_f32 v[52:53], v[52:53], v[60:61]
    v_pk_add_f32 v[54:55], v[54:55], v[62:63]
    v_pk_add_f32 v[48:49], v[48:49], v[52:53]
    v_pk_add_f32 v[50:51], v[50:51], v[54:55]
    buffer_store_dwordx4 v[48:51], v6, s[20:23], s48 offen offset:2048 sc1
    s_waitcnt lgkmcnt(4)
    v_pk_add_f32 v[64:65], v[64:65], v[72:73]
    v_pk_add_f32 v[66:67], v[66:67], v[74:75]
    v_pk_add_f32 v[68:69], v[68:69], v[76:77]
    v_pk_add_f32 v[70:71], v[70:71], v[78:79]
    v_pk_add_f32 v[64:65], v[64:65], v[68:69]
    v_pk_add_f32 v[66:67], v[66:67], v[70:71]
    buffer_store_dwordx4 v[64:67], v6, s[20:23], s48 offen offset:3072 sc1
    s_waitcnt lgkmcnt(0)
    v_pk_add_f32 v[80:81], v[80:81], v[88:89]
    v_pk_add_f32 v[82:83], v[82:83], v[90:91]
    v_pk_add_f32 v[84:85], v[84:85], v[92:93]
    v_pk_add_f32 v[86:87], v[86:87], v[94:95]
    v_pk_add_f32 v[80:81], v[80:81], v[84:85]
    v_pk_add_f32 v[82:83], v[82:83], v[86:87]
    buffer_store_dwordx4 v[80:83], v6, s[20:23], s49 offen offset:0 sc1
    v_mov_b32 v12, 1
    v_mov_b32 v11, s52
    s_waitcnt vmcnt(0)
    s_mov_b64 exec, 1
    buffer_atomic_add v12, v11, s[24:27], 0 offen sc1
    s_mov_b64 exec, -1
K2_NL:
    s_waitcnt vmcnt(8)
    v_mfma_f32_32x32x16_bf16 v[48:63], v[182:185], v[96:99], 0
    v_mfma_f32_32x32x8bf16_1k v[48:63], v[186:187], v[100:101], v[48:63]
    v_mfma_f32_32x32x16_bf16 v[64:79], v[182:185], v[102:105], 0
    v_mfma_f32_32x32x8bf16_1k v[64:79], v[186:187], v[106:107], v[64:79]
    s_nop 9
    v_max3_f32 v10, v48, v49, v50
    v_max3_f32 v10, v10, v51, v52
    v_max3_f32 v10, v10, v53, v54
    v_max3_f32 v10, v10, v55, v56
    v_max3_f32 v10, v10, v57, v58
    v_max3_f32 v10, v10, v59, v60
    v_max3_f32 v10, v10, v61, v62
    v_max_f32 v10, v10, v63
    v_mov_b32 v14, v10
    s_nop 1
    v_permlane32_swap_b32 v14, v10
    v_max_f32 v10, v10, v14
    v_sub_f32 v10, 0, v10
    v_and_b32 v14, 0xffff0000, v10
    v_sub_f32 v15, v10, v14
    v_cvt_pk_bf16_f32 v14, v14, v15
    v_cndmask_b32 v100, v100, v14, s[64:65]
    v_max3_f32 v10, v64, v65, v66
    v_max3_f32 v10, v10, v67, v68
    v_max3_f32 v10, v10, v69, v70
    v_max3_f32 v10, v10, v71, v72
    v_max3_f32 v10, v10, v73, v74
    v_max3_f32 v10, v10, v75, v76
    v_max3_f32 v10, v10, v77, v78
    v_max_f32 v10, v10, v79
    v_mov_b32 v14, v10
    s_nop 1
    v_permlane32_swap_b32 v14, v10
    v_max_f32 v10, v10, v14
    v_sub_f32 v10, 0, v10
    v_and_b32 v14, 0xffff0000, v10
    v_sub_f32 v15, v10, v14
    v_cvt_pk_bf16_f32 v14, v14, v15
    v_cndmask_b32 v106, v106, v14, s[64:65]
    s_setprio 1
K2_GO:
    v_mfma_f32_32x32x16_bf16 v[16:31], v[108:111], v[96:99], 0
    v_mfma_f32_32x32x8bf16_1k v[16:31], v[112:113], v[100:101], v[16:31]
    v_mov_b32 v48, 0
    v_mov_b32 v49, 0
    v_mov_b32 v50, 0
    v_mov_b32 v51, 0
    v_mov_b32 v52, 0
    v_mov_b32 v53, 0
    v_mov_b32 v54, 0
    v_mov_b32 v55, 0
    v_mov_b32 v56, 0
    v_mov_b32 v57, 0
    v_mov_b32 v58, 0
    v_mov_b32 v59, 0
    v_mov_b32 v60, 0
    v_mov_b32 v61, 0
    v_mov_b32 v62, 0
    v_mov_b32 v63, 0
    v_mov_b32 v64, 0
    v_mov_b32 v65, 0
    v_mov_b32 v66, 0
    v_mov_b32 v67, 0
    v_mov_b32 v68, 0
    v_mov_b32 v69, 0
    v_mov_b32 v70, 0
    v_mov_b32 v71, 0
    v_mov_b32 v72, 0
    v_mov_b32 v73, 0
    v_mov_b32 v74, 0
    v_mov_b32 v75, 0
    v_mov_b32 v76, 0
    v_mov_b32 v77, 0
    v_mov_b32 v78, 0
    v_mov_b32 v79, 0
    v_mov_b32 v88, 0
    v_mov_b32 v89, 0
    v_mov_b32 v90, 0
    v_mov_b32 v91, 0
    v_mov_b32 v92, 0
    v_mov_b32 v93, 0
    v_mov_b32 v94, 0
    v_mov_b32 v95, 0
    s_mov_b32 s53, 0
K2_LOOP:
    v_mfma_f32_32x32x16_bf16 v[32:47], v[108:111], v[102:105], 0
    v_exp_f32 v16, v16
    v_exp_f32 v17, v17
    v_exp_f32 v18, v18
    v_exp_f32 v19, v19
    v_cvt_pk_bf16_f32 v80, v16, v17
    v_cvt_pk_bf16_f32 v81, v18, v19
    v_mfma_f32_32x32x16_bf16 v[64:79], v[156:159], v[88:91], v[64:79]
    v_exp_f32 v20, v20
    v_exp_f32 v21, v21
    v_exp_f32 v22, v22
    v_exp_f32 v23, v23
    v_cvt_pk_bf16_f32 v82, v20, v21
    v_cvt_pk_bf16_f32 v83, v22, v23
    v_mfma_f32_32x32x8bf16_1k v[32:47], v[112:113], v[106:107], v[32:47]
    v_exp_f32 v24, v24
    v_exp_f32 v25, v25
    v_exp_f32 v26, v26
    v_exp_f32 v27, v27
    v_cvt_pk_bf16_f32 v84, v24, v25
    v_cvt_pk_bf16_f32 v85, v26, v27
    v_mfma_f32_32x32x16_bf16 v[64:79], v[160:163], v[92:95], v[64:79]
    v_exp_f32 v28, v28
    v_exp_f32 v29, v29
    v_exp_f32 v30, v30
    v_exp_f32 v31, v31
    v_cvt_pk_bf16_f32 v86, v28, v29
    v_cvt_pk_bf16_f32 v87, v30, v31
    s_waitcnt vmcnt(4)
    s_mov_b64 exec, s[60:61]
    buffer_load_dwordx2 v[154:155], v4, s[20:23], s47 offen
    s_mov_b64 exec, s[62:63]
    buffer_load_dwordx4 v[156:159], v5, s[20:23], s47 offen
    buffer_load_dwordx4 v[160:163], v5, s[20:23], s47 offen offset:640
    s_mov_b64 exec, -1
    buffer_load_dwordx4 v[150:153], v3, s[20:23], s47 offen
    s_add_u32 s47, s47, 5120
    s_cmp_eq_u32 s47, s67
    s_cselect_b32 s47, s66, s47
    v_mfma_f32_32x32x16_bf16 v[16:31], v[122:125], v[96:99], 0
    v_exp_f32 v32, v32
    v_exp_f32 v33, v33
    v_exp_f32 v34, v34
    v_exp_f32 v35, v35
    v_cvt_pk_bf16_f32 v88, v32, v33
    v_cvt_pk_bf16_f32 v89, v34, v35
    v_mfma_f32_32x32x16_bf16 v[48:63], v[114:117], v[80:83], v[48:63]
    v_exp_f32 v36, v36
    v_exp_f32 v37, v37
    v_exp_f32 v38, v38
    v_exp_f32 v39, v39
    v_cvt_pk_bf16_f32 v90, v36, v37
    v_cvt_pk_bf16_f32 v91, v38, v39
    v_mfma_f32_32x32x8bf16_1k v[16:31], v[126:127], v[100:101], v[16:31]
    v_exp_f32 v40, v40
    v_exp_f32 v41, v41
    v_exp_f32 v42, v42
    v_exp_f32 v43, v43
    v_cvt_pk_bf16_f32 v92, v40, v41
    v_cvt_pk_bf16_f32 v93, v42, v43
    v_mfma_f32_32x32x16_bf16 v[48:63], v[118:121], v[84:87], v[48:63]
    v_exp_f32 v44, v44
    v_exp_f32 v45, v45
    v_exp_f32 v46, v46
    v_exp_f32 v47, v47
    v_cvt_pk_bf16_f32 v94, v44, v45
    v_cvt_pk_bf16_f32 v95, v46, v47
    v_mfma_f32_32x32x16_bf16 v[32:47], v[122:125], v[102:105], 0
    v_exp_f32 v16, v16
    v_exp_f32 v17, v17
    v_exp_f32 v18, v18
    v_exp_f32 v19, v19
    v_cvt_pk_bf16_f32 v80, v16, v17
    v_cvt_pk_bf16_f32 v81, v18, v19
    v_mfma_f32_32x32x16_bf16 v[64:79], v[114:117], v[88:91], v[64:79]
    v_exp_f32 v20, v20
    v_exp_f32 v21, v21
    v_exp_f32 v22, v22
    v_exp_f32 v23, v23
    v_cvt_pk_bf16_f32 v82, v20, v21
    v_cvt_pk_bf16_f32 v83, v22, v23
    v_mfma_f32_32x32x8bf16_1k v[32:47], v[126:127], v[106:107], v[32:47]
    v_exp_f32 v24, v24
    v_exp_f32 v25, v25
    v_exp_f32 v26, v26
    v_exp_f32 v27, v27
    v_cvt_pk_bf16_f32 v84, v24, v25
    v_cvt_pk_bf16_f32 v85, v26, v27
    v_mfma_f32_32x32x16_bf16 v[64:79], v[118:121], v[92:95], v[64:79]
    v_exp_f32 v28, v28
    v_exp_f32 v29, v29
    v_exp_f32 v30, v30
    v_exp_f32 v31, v31
    v_cvt_pk_bf16_f32 v86, v28, v29
    v_cvt_pk_bf16_f32 v87, v30, v31
    s_waitcnt vmcnt(4)
    s_mov_b64 exec, s[60:61]
    buffer_load_dwordx2 v[112:113], v4, s[20:23], s47 offen
    s_mov_b64 exec, s[62:63]
    buffer_load_dwordx4 v[114:117], v5, s[20:23], s47 offen
    buffer_load_dwordx4 v[118:121], v5, s[20:23], s47 offen offset:640
    s_mov_b64 exec, -1
    buffer_load_dwordx4 v[108:111], v3, s[20:23], s47 offen
    s_add_u32 s47, s47, 5120
    s_cmp_eq_u32 s47, s67
    s_cselect_b32 s47, s66, s47
    v_mfma_f32_32x32x16_bf16 v[16:31], v[136:139], v[96:99], 0
    v_exp_f32 v32, v32
    v_exp_f32 v33, v33
    v_exp_f32 v34, v34
    v_exp_f32 v35, v35
    v_cvt_pk_bf16_f32 v88, v32, v33
    v_cvt_pk_bf16_f32 v89, v34, v35
    v_mfma_f32_32x32x16_bf16 v[48:63], v[128:131], v[80:83], v[48:63]
    v_exp_f32 v36, v36
    v_exp_f32 v37, v37
    v_exp_f32 v38, v38
    v_exp_f32 v39, v39
    v_cvt_pk_bf16_f32 v90, v36, v37
    v_cvt_pk_bf16_f32 v91, v38, v39
    v_mfma_f32_32x32x8bf16_1k v[16:31], v[140:141], v[100:101], v[16:31]
    v_exp_f32 v40, v40
    v_exp_f32 v41, v41
    v_exp_f32 v42, v42
    v_exp_f32 v43, v43
    v_cvt_pk_bf16_f32 v92, v40, v41
    v_cvt_pk_bf16_f32 v93, v42, v43
    v_mfma_f32_32x32x16_bf16 v[48:63], v[132:135], v[84:87], v[48:63]
    v_exp_f32 v44, v44
    v_exp_f32 v45, v45
    v_exp_f32 v46, v46
    v_exp_f32 v47, v47
    v_cvt_pk_bf16_f32 v94, v44, v45
    v_cvt_pk_bf16_f32 v95, v46, v47
    v_mfma_f32_32x32x16_bf16 v[32:47], v[136:139], v[102:105], 0
    v_exp_f32 v16, v16
    v_exp_f32 v17, v17
    v_exp_f32 v18, v18
    v_exp_f32 v19, v19
    v_cvt_pk_bf16_f32 v80, v16, v17
    v_cvt_pk_bf16_f32 v81, v18, v19
    v_mfma_f32_32x32x16_bf16 v[64:79], v[128:131], v[88:91], v[64:79]
    v_exp_f32 v20, v20
    v_exp_f32 v21, v21
    v_exp_f32 v22, v22
    v_exp_f32 v23, v23
    v_cvt_pk_bf16_f32 v82, v20, v21
    v_cvt_pk_bf16_f32 v83, v22, v23
    v_mfma_f32_32x32x8bf16_1k v[32:47], v[140:141], v[106:107], v[32:47]
    v_exp_f32 v24, v24
    v_exp_f32 v25, v25
    v_exp_f32 v26, v26
    v_exp_f32 v27, v27
    v_cvt_pk_bf16_f32 v84, v24, v25
    v_cvt_pk_bf16_f32 v85, v26, v27
    v_mfma_f32_32x32x16_bf16 v[64:79], v[132:135], v[92:95], v[64:79]
    v_exp_f32 v28, v28
    v_exp_f32 v29, v29
    v_exp_f32 v30, v30
    v_exp_f32 v31, v31
    v_cvt_pk_bf16_f32 v86, v28, v29
    v_cvt_pk_bf16_f32 v87, v30, v31
    s_waitcnt vmcnt(4)
    s_mov_b64 exec, s[60:61]
    buffer_load_dwordx2 v[126:127], v4, s[20:23], s47 offen
    s_mov_b64 exec, s[62:63]
    buffer_load_dwordx4 v[128:131], v5, s[20:23], s47 offen
    buffer_load_dwordx4 v[132:135], v5, s[20:23], s47 offen offset:640
    s_mov_b64 exec, -1
    buffer_load_dwordx4 v[122:125], v3, s[20:23], s47 offen
    s_add_u32 s47, s47, 5120
    s_cmp_eq_u32 s47, s67
    s_cselect_b32 s47, s66, s47
    v_mfma_f32_32x32x16_bf16 v[16:31], v[150:153], v[96:99], 0
    v_exp_f32 v32, v32
    v_exp_f32 v33, v33
    v_exp_f32 v34, v34
    v_exp_f32 v35, v35
    v_cvt_pk_bf16_f32 v88, v32, v33
    v_cvt_pk_bf16_f32 v89, v34, v35
    v_mfma_f32_32x32x16_bf16 v[48:63], v[142:145], v[80:83], v[48:63]
    v_exp_f32 v36, v36
    v_exp_f32 v37, v37
    v_exp_f32 v38, v38
    v_exp_f32 v39, v39
    v_cvt_pk_bf16_f32 v90, v36, v37
    v_cvt_pk_bf16_f32 v91, v38, v39
    v_mfma_f32_32x32x8bf16_1k v[16:31], v[154:155], v[100:101], v[16:31]
    v_exp_f32 v40, v40
    v_exp_f32 v41, v41
    v_exp_f32 v42, v42
    v_exp_f32 v43, v43
    v_cvt_pk_bf16_f32 v92, v40, v41
    v_cvt_pk_bf16_f32 v93, v42, v43
    v_mfma_f32_32x32x16_bf16 v[48:63], v[146:149], v[84:87], v[48:63]
    v_exp_f32 v44, v44
    v_exp_f32 v45, v45
    v_exp_f32 v46, v46
    v_exp_f32 v47, v47
    v_cvt_pk_bf16_f32 v94, v44, v45
    v_cvt_pk_bf16_f32 v95, v46, v47
    v_mfma_f32_32x32x16_bf16 v[32:47], v[150:153], v[102:105], 0
    v_exp_f32 v16, v16
    v_exp_f32 v17, v17
    v_exp_f32 v18, v18
    v_exp_f32 v19, v19
    v_cvt_pk_bf16_f32 v80, v16, v17
    v_cvt_pk_bf16_f32 v81, v18, v19
    v_mfma_f32_32x32x16_bf16 v[64:79], v[142:145], v[88:91], v[64:79]
    v_exp_f32 v20, v20
    v_exp_f32 v21, v21
    v_exp_f32 v22, v22
    v_exp_f32 v23, v23
    v_cvt_pk_bf16_f32 v82, v20, v21
    v_cvt_pk_bf16_f32 v83, v22, v23
    v_mfma_f32_32x32x8bf16_1k v[32:47], v[154:155], v[106:107], v[32:47]
    v_exp_f32 v24, v24
    v_exp_f32 v25, v25
    v_exp_f32 v26, v26
    v_exp_f32 v27, v27
    v_cvt_pk_bf16_f32 v84, v24, v25
    v_cvt_pk_bf16_f32 v85, v26, v27
    v_mfma_f32_32x32x16_bf16 v[64:79], v[146:149], v[92:95], v[64:79]
    v_exp_f32 v28, v28
    v_exp_f32 v29, v29
    v_exp_f32 v30, v30
    v_exp_f32 v31, v31
    v_cvt_pk_bf16_f32 v86, v28, v29
    v_cvt_pk_bf16_f32 v87, v30, v31
    s_waitcnt vmcnt(4)
    s_mov_b64 exec, s[60:61]
    buffer_load_dwordx2 v[140:141], v4, s[20:23], s47 offen
    s_mov_b64 exec, s[62:63]
    buffer_load_dwordx4 v[142:145], v5, s[20:23], s47 offen
    buffer_load_dwordx4 v[146:149], v5, s[20:23], s47 offen offset:640
    s_mov_b64 exec, -1
    buffer_load_dwordx4 v[136:139], v3, s[20:23], s47 offen
    s_add_u32 s47, s47, 5120
    s_cmp_eq_u32 s47, s67
    s_cselect_b32 s47, s66, s47
    v_mfma_f32_32x32x16_bf16 v[16:31], v[108:111], v[96:99], 0
    v_exp_f32 v32, v32
    v_exp_f32 v33, v33
    v_exp_f32 v34, v34
    v_exp_f32 v35, v35
    v_cvt_pk_bf16_f32 v88, v32, v33
    v_cvt_pk_bf16_f32 v89, v34, v35
    v_mfma_f32_32x32x16_bf16 v[48:63], v[156:159], v[80:83], v[48:63]
    v_exp_f32 v36, v36
    v_exp_f32 v37, v37
    v_exp_f32 v38, v38
    v_exp_f32 v39, v39
    v_cvt_pk_bf16_f32 v90, v36, v37
    v_cvt_pk_bf16_f32 v91, v38, v39
    v_mfma_f32_32x32x8bf16_1k v[16:31], v[112:113], v[100:101], v[16:31]
    v_exp_f32 v40, v40
    v_exp_f32 v41, v41
    v_exp_f32 v42, v42
    v_exp_f32 v43, v43
    v_cvt_pk_bf16_f32 v92, v40, v41
    v_cvt_pk_bf16_f32 v93, v42, v43
    v_mfma_f32_32x32x16_bf16 v[48:63], v[160:163], v[84:87], v[48:63]
    v_exp_f32 v44, v44
    v_exp_f32 v45, v45
    v_exp_f32 v46, v46
    v_exp_f32 v47, v47
    v_cvt_pk_bf16_f32 v94, v44, v45
    v_cvt_pk_bf16_f32 v95, v46, v47
    s_add_u32 s53, s53, 1
    s_cmp_lt_u32 s53, 8
    s_cbranch_scc1 K2_LOOP
    v_mfma_f32_32x32x16_bf16 v[64:79], v[156:159], v[88:91], v[64:79]
    v_mfma_f32_32x32x16_bf16 v[64:79], v[160:163], v[92:95], v[64:79]
    s_lshl_b32 s48, s34, 6
    s_sub_u32 s48, 64, s48
    s_add_u32 s48, s48, s42
    s_mul_i32 s54, s48, 0xa000
    s_add_u32 s54, s54, 15728640
    s_lshl_b32 s56, s28, 10
    s_lshl_b32 s57, s28, 8
    s_add_u32 s57, s57, 0x8000
    s_add_u32 s57, s54, s57
    s_add_u32 s54, s54, s56
    s_add_u32 s55, s54, 0xa000
    s_add_u32 s58, s57, 0xa000
    s_lshl_b32 s48, s35, 13
    v_add_u32 v7, s48, v6
    s_lshl_b32 s48, s35, 2
    s_add_u32 s48, s48, 58384
    v_mov_b32 v9, s48
    s_cmp_eq_u32 s34, 0
    s_cbranch_scc0 K2_BT
    ds_write_b128 v7, v[48:51] offset:0
    ds_write_b128 v7, v[52:55] offset:1024
    ds_write_b128 v7, v[56:59] offset:2048
    ds_write_b128 v7, v[60:63] offset:3072
    ds_write_b128 v7, v[64:67] offset:4096
    ds_write_b128 v7, v[68:71] offset:5120
    ds_write_b128 v7, v[72:75] offset:6144
    ds_write_b128 v7, v[76:79] offset:7168
    v_mov_b32 v11, s52
    v_mov_b32 v12, 1
    s_waitcnt lgkmcnt(0)
    ds_write_b32 v9, v12
    s_mov_b32 s48, 0
K2_P1:
    buffer_load_dword v10, v11, s[24:27], 0 offen sc1
    s_add_u32 s48, s48, 1
    s_waitcnt vmcnt(0)
    v_readfirstlane_b32 s49, v10
    s_nop 0
    s_cmp_ge_u32 s49, 8
    s_cbranch_scc1 K2_P2
    s_sleep 8
    s_cmp_lt_u32 s48, 0x20000
    s_cbranch_scc1 K2_P1
K2_P2:
    s_mul_i32 s49, s28, 0xa000
    s_add_u32 s49, s49, 20971520
    s_lshl_b32 s48, s35, 10
    v_add_u32 v7, s48, v6
    s_lshl_b32 s48, s35, 8
    s_add_u32 s48, s48, 0x1000
    v_add_u32 v9, s48, v6
    buffer_load_dwordx4 v[188:191], v7, s[20:23], s49 offen sc1
    s_mov_b64 exec, 0xffff
    buffer_load_dwordx4 v[48:51], v9, s[20:23], s49 offen sc1
    s_mov_b64 exec, -1
    s_add_u32 s49, s49, 0x1400
    buffer_load_dwordx4 v[192:195], v7, s[20:23], s49 offen sc1
    s_mov_b64 exec, 0xffff
    buffer_load_dwordx4 v[52:55], v9, s[20:23], s49 offen sc1
    s_mov_b64 exec, -1
    s_add_u32 s49, s49, 0x1400
    buffer_load_dwordx4 v[196:199], v7, s[20:23], s49 offen sc1
    s_mov_b64 exec, 0xffff
    buffer_load_dwordx4 v[56:59], v9, s[20:23], s49 offen sc1
    s_mov_b64 exec, -1
    s_add_u32 s49, s49, 0x1400
    buffer_load_dwordx4 v[200:203], v7, s[20:23], s49 offen sc1
    s_mov_b64 exec, 0xffff
    buffer_load_dwordx4 v[60:63], v9, s[20:23], s49 offen sc1
    s_mov_b64 exec, -1
    s_add_u32 s49, s49, 0x1400
    buffer_load_dwordx4 v[204:207], v7, s[20:23], s49 offen sc1
    s_mov_b64 exec, 0xffff
    buffer_load_dwordx4 v[64:67], v9, s[20:23], s49 offen sc1
    s_mov_b64 exec, -1
    s_add_u32 s49, s49, 0x1400
    buffer_load_dwordx4 v[208:211], v7, s[20:23], s49 offen sc1
    s_mov_b64 exec, 0xffff
    buffer_load_dwordx4 v[68:71], v9, s[20:23], s49 offen sc1
    s_mov_b64 exec, -1
    s_add_u32 s49, s49, 0x1400
    buffer_load_dwordx4 v[212:215], v7, s[20:23], s49 offen sc1
    s_mov_b64 exec, 0xffff
    buffer_load_dwordx4 v[72:75], v9, s[20:23], s49 offen sc1
    s_mov_b64 exec, -1
    s_add_u32 s49, s49, 0x1400
    buffer_load_dwordx4 v[216:219], v7, s[20:23], s49 offen sc1
    s_mov_b64 exec, 0xffff
    buffer_load_dwordx4 v[76:79], v9, s[20:23], s49 offen sc1
    s_mov_b64 exec, -1
    s_add_u32 s49, s49, 0x1400
    v_mfma_f32_32x32x16_bf16 v[16:31], v[164:167], v[170:173], 0
    v_mfma_f32_32x32x8bf16_1k v[16:31], v[168:169], v[174:175], v[16:31]
    s_nop 11
    v_max3_f32 v10, v16, v17, v18
    v_max3_f32 v10, v10, v19, v20
    v_max3_f32 v10, v10, v21, v22
    v_max3_f32 v10, v10, v23, v24
    v_max_f32 v10, v10, v25
    v_min3_f32 v11, v16, v17, v18
    v_min3_f32 v11, v11, v19, v20
    v_min3_f32 v11, v11, v21, v22
    v_min3_f32 v11, v11, v23, v24
    v_min_f32 v11, v11, v25
    v_mov_b32 v14, v10
    s_nop 1
    v_permlane32_swap_b32 v14, v10
    v_max_f32 v10, v10, v14
    v_mov_b32 v15, v11
    s_nop 1
    v_permlane32_swap_b32 v15, v11
    v_min_f32 v11, v11, v15
    v_sub_f32 v32, v11, v16
    v_sub_f32 v33, v11, v17
    v_sub_f32 v34, v11, v18
    v_sub_f32 v35, v11, v19
    v_sub_f32 v36, v11, v20
    v_sub_f32 v37, v11, v21
    v_sub_f32 v38, v11, v22
    v_sub_f32 v39, v11, v23
    v_sub_f32 v40, v11, v24
    v_sub_f32 v41, v11, v25
    v_sub_f32 v16, v16, v10
    v_sub_f32 v17, v17, v10
    v_sub_f32 v18, v18, v10
    v_sub_f32 v19, v19, v10
    v_sub_f32 v20, v20, v10
    v_sub_f32 v21, v21, v10
    v_sub_f32 v22, v22, v10
    v_sub_f32 v23, v23, v10
    v_sub_f32 v24, v24, v10
    v_sub_f32 v25, v25, v10
    v_exp_f32 v32, v32
    v_exp_f32 v33, v33
    v_exp_f32 v34, v34
    v_exp_f32 v35, v35
    v_exp_f32 v36, v36
    v_exp_f32 v37, v37
    v_exp_f32 v38, v38
    v_exp_f32 v39, v39
    v_exp_f32 v40, v40
    v_exp_f32 v41, v41
    v_exp_f32 v16, v16
    v_exp_f32 v17, v17
    v_exp_f32 v18, v18
    v_exp_f32 v19, v19
    v_exp_f32 v20, v20
    v_exp_f32 v21, v21
    v_exp_f32 v22, v22
    v_exp_f32 v23, v23
    v_exp_f32 v24, v24
    v_exp_f32 v25, v25
    v_pk_add_f32 v[14:15], v[32:33], v[34:35]
    v_pk_add_f32 v[14:15], v[14:15], v[36:37]
    v_pk_add_f32 v[14:15], v[14:15], v[38:39]
    v_pk_add_f32 v[14:15], v[14:15], v[40:41]
    v_add_f32 v13, v14, v15
    v_pk_add_f32 v[14:15], v[16:17], v[18:19]
    v_pk_add_f32 v[14:15], v[14:15], v[20:21]
    v_pk_add_f32 v[14:15], v[14:15], v[22:23]
    v_pk_add_f32 v[14:15], v[14:15], v[24:25]
    v_add_f32 v12, v14, v15
    v_mov_b32 v14, v12
    s_nop 1
    v_permlane32_swap_b32 v14, v12
    v_add_f32 v12, v12, v14
    v_mov_b32 v15, v13
    s_nop 1
    v_permlane32_swap_b32 v15, v13
    v_add_f32 v13, v13, v15
    v_rcp_f32 v12, v12
    v_rcp_f32 v14, v13
    v_mov_b32 v13, v12
    v_mov_b32 v15, v14
    v_pk_mul_f32 v[16:17], v[16:17], v[12:13]
    v_pk_mul_f32 v[18:19], v[18:19], v[12:13]
    v_pk_mul_f32 v[20:21], v[20:21], v[12:13]
    v_pk_mul_f32 v[22:23], v[22:23], v[12:13]
    v_pk_mul_f32 v[24:25], v[24:25], v[12:13]
    v_pk_mul_f32 v[32:33], v[32:33], v[14:15]
    v_pk_mul_f32 v[34:35], v[34:35], v[14:15]
    v_pk_mul_f32 v[36:37], v[36:37], v[14:15]
    v_pk_mul_f32 v[38:39], v[38:39], v[14:15]
    v_pk_mul_f32 v[40:41], v[40:41], v[14:15]
    s_waitcnt vmcnt(16)
    v_cvt_pk_bf16_f32 v108, v16, v17
    v_cvt_pk_bf16_f32 v112, v32, v33
    v_cvt_pk_bf16_f32 v109, v18, v19
    v_cvt_pk_bf16_f32 v113, v34, v35
    v_cvt_pk_bf16_f32 v110, v20, v21
    v_cvt_pk_bf16_f32 v114, v36, v37
    v_cvt_pk_bf16_f32 v111, v22, v23
    v_cvt_pk_bf16_f32 v115, v38, v39
    v_cvt_pk_bf16_f32 v116, v24, v25
    v_cvt_pk_bf16_f32 v117, v40, v41
    v_mfma_f32_32x32x16_bf16 v[16:31], v[164:167], v[176:179], 0
    v_mfma_f32_32x32x8bf16_1k v[16:31], v[168:169], v[180:181], v[16:31]
    s_nop 11
    v_max3_f32 v10, v16, v17, v18
    v_max3_f32 v10, v10, v19, v20
    v_max3_f32 v10, v10, v21, v22
    v_max3_f32 v10, v10, v23, v24
    v_max_f32 v10, v10, v25
    v_min3_f32 v11, v16, v17, v18
    v_min3_f32 v11, v11, v19, v20
    v_min3_f32 v11, v11, v21, v22
    v_min3_f32 v11, v11, v23, v24
    v_min_f32 v11, v11, v25
    v_mov_b32 v14, v10
    s_nop 1
    v_permlane32_swap_b32 v14, v10
    v_max_f32 v10, v10, v14
    v_mov_b32 v15, v11
    s_nop 1
    v_permlane32_swap_b32 v15, v11
    v_min_f32 v11, v11, v15
    v_sub_f32 v32, v11, v16
    v_sub_f32 v33, v11, v17
    v_sub_f32 v34, v11, v18
    v_sub_f32 v35, v11, v19
    v_sub_f32 v36, v11, v20
    v_sub_f32 v37, v11, v21
    v_sub_f32 v38, v11, v22
    v_sub_f32 v39, v11, v23
    v_sub_f32 v40, v11, v24
    v_sub_f32 v41, v11, v25
    v_sub_f32 v16, v16, v10
    v_sub_f32 v17, v17, v10
    v_sub_f32 v18, v18, v10
    v_sub_f32 v19, v19, v10
    v_sub_f32 v20, v20, v10
    v_sub_f32 v21, v21, v10
    v_sub_f32 v22, v22, v10
    v_sub_f32 v23, v23, v10
    v_sub_f32 v24, v24, v10
    v_sub_f32 v25, v25, v10
    v_exp_f32 v32, v32
    v_exp_f32 v33, v33
    v_exp_f32 v34, v34
    v_exp_f32 v35, v35
    v_exp_f32 v36, v36
    v_exp_f32 v37, v37
    v_exp_f32 v38, v38
    v_exp_f32 v39, v39
    v_exp_f32 v40, v40
    v_exp_f32 v41, v41
    v_exp_f32 v16, v16
    v_exp_f32 v17, v17
    v_exp_f32 v18, v18
    v_exp_f32 v19, v19
    v_exp_f32 v20, v20
    v_exp_f32 v21, v21
    v_exp_f32 v22, v22
    v_exp_f32 v23, v23
    v_exp_f32 v24, v24
    v_exp_f32 v25, v25
    v_pk_add_f32 v[14:15], v[32:33], v[34:35]
    v_pk_add_f32 v[14:15], v[14:15], v[36:37]
    v_pk_add_f32 v[14:15], v[14:15], v[38:39]
    v_pk_add_f32 v[14:15], v[14:15], v[40:41]
    v_add_f32 v13, v14, v15
    v_pk_add_f32 v[14:15], v[16:17], v[18:19]
    v_pk_add_f32 v[14:15], v[14:15], v[20:21]
    v_pk_add_f32 v[14:15], v[14:15], v[22:23]
    v_pk_add_f32 v[14:15], v[14:15], v[24:25]
    v_add_f32 v12, v14, v15
    v_mov_b32 v14, v12
    s_nop 1
    v_permlane32_swap_b32 v14, v12
    v_add_f32 v12, v12, v14
    v_mov_b32 v15, v13
    s_nop 1
    v_permlane32_swap_b32 v15, v13
    v_add_f32 v13, v13, v15
    v_rcp_f32 v12, v12
    v_rcp_f32 v14, v13
    v_mov_b32 v13, v12
    v_mov_b32 v15, v14
    v_pk_mul_f32 v[16:17], v[16:17], v[12:13]
    v_pk_mul_f32 v[18:19], v[18:19], v[12:13]
    v_pk_mul_f32 v[20:21], v[20:21], v[12:13]
    v_pk_mul_f32 v[22:23], v[22:23], v[12:13]
    v_pk_mul_f32 v[24:25], v[24:25], v[12:13]
    v_pk_mul_f32 v[32:33], v[32:33], v[14:15]
    v_pk_mul_f32 v[34:35], v[34:35], v[14:15]
    v_pk_mul_f32 v[36:37], v[36:37], v[14:15]
    v_pk_mul_f32 v[38:39], v[38:39], v[14:15]
    v_pk_mul_f32 v[40:41], v[40:41], v[14:15]
    v_cvt_pk_bf16_f32 v118, v16, v17
    v_cvt_pk_bf16_f32 v122, v32, v33
    v_cvt_pk_bf16_f32 v119, v18, v19
    v_cvt_pk_bf16_f32 v123, v34, v35
    v_cvt_pk_bf16_f32 v120, v20, v21
    v_cvt_pk_bf16_f32 v124, v36, v37
    v_cvt_pk_bf16_f32 v121, v22, v23
    v_cvt_pk_bf16_f32 v125, v38, v39
    v_cvt_pk_bf16_f32 v126, v24, v25
    v_cvt_pk_bf16_f32 v127, v40, v41
    s_waitcnt vmcnt(0)
    v_pk_add_f32 v[188:189], v[188:189], v[204:205]
    v_pk_add_f32 v[190:191], v[190:191], v[206:207]
    v_pk_add_f32 v[192:193], v[192:193], v[208:209]
    v_pk_add_f32 v[194:195], v[194:195], v[210:211]
    v_pk_add_f32 v[196:197], v[196:197], v[212:213]
    v_pk_add_f32 v[198:199], v[198:199], v[214:215]
    v_pk_add_f32 v[200:201], v[200:201], v[216:217]
    v_pk_add_f32 v[202:203], v[202:203], v[218:219]
    v_pk_add_f32 v[188:189], v[188:189], v[196:197]
    v_pk_add_f32 v[190:191], v[190:191], v[198:199]
    v_pk_add_f32 v[192:193], v[192:193], v[200:201]
    v_pk_add_f32 v[194:195], v[194:195], v[202:203]
    v_pk_add_f32 v[188:189], v[188:189], v[192:193]
    v_pk_add_f32 v[190:191], v[190:191], v[194:195]
    v_pk_add_f32 v[48:49], v[48:49], v[64:65]
    v_pk_add_f32 v[50:51], v[50:51], v[66:67]
    v_pk_add_f32 v[52:53], v[52:53], v[68:69]
    v_pk_add_f32 v[54:55], v[54:55], v[70:71]
    v_pk_add_f32 v[56:57], v[56:57], v[72:73]
    v_pk_add_f32 v[58:59], v[58:59], v[74:75]
    v_pk_add_f32 v[60:61], v[60:61], v[76:77]
    v_pk_add_f32 v[62:63], v[62:63], v[78:79]
    v_pk_add_f32 v[48:49], v[48:49], v[56:57]
    v_pk_add_f32 v[50:51], v[50:51], v[58:59]
    v_pk_add_f32 v[52:53], v[52:53], v[60:61]
    v_pk_add_f32 v[54:55], v[54:55], v[62:63]
    v_pk_add_f32 v[48:49], v[48:49], v[52:53]
    v_pk_add_f32 v[50:51], v[50:51], v[54:55]
    ds_write_b128 v7, v[188:191] offset:53248
    s_mov_b64 exec, 0xffff
    ds_write_b128 v9, v[48:51] offset:53248
    s_mov_b64 exec, 1
    v_mov_b32 v11, 58372
    v_mov_b32 v12, 1
    s_waitcnt lgkmcnt(0)
    ds_add_u32 v11, v12
K2_P3:
    ds_read_b32 v10, v11
    s_waitcnt lgkmcnt(0)
    v_readfirstlane_b32 s49, v10
    s_nop 0
    s_cmp_lt_u32 s49, 4
    s_cbranch_scc1 K2_P3
    s_mov_b64 exec, -1
    ds_read_b128 v[188:191], v6 offset:53248
    ds_read_b128 v[192:195], v6 offset:54272
    ds_read_b128 v[196:199], v6 offset:55296
    ds_read_b128 v[200:203], v6 offset:56320
    ds_read_b128 v[204:207], v6 offset:57344
    s_waitcnt lgkmcnt(0)
    v_cvt_pk_bf16_f32 v208, v188, v189
    v_cvt_pk_bf16_f32 v209, v190, v191
    v_cvt_pk_bf16_f32 v210, v192, v193
    v_cvt_pk_bf16_f32 v211, v194, v195
    v_cvt_pk_bf16_f32 v212, v196, v197
    v_cvt_pk_bf16_f32 v213, v198, v199
    v_cvt_pk_bf16_f32 v214, v200, v201
    v_cvt_pk_bf16_f32 v215, v202, v203
    v_cvt_pk_bf16_f32 v216, v204, v205
    v_cvt_pk_bf16_f32 v217, v206, v207
    v_mfma_f32_32x32x16_bf16 v[16:31], v[208:211], v[108:111], 0
    v_mfma_f32_32x32x16_bf16 v[16:31], v[212:215], v[112:115], v[16:31]
    v_mfma_f32_32x32x8bf16_1k v[16:31], v[216:217], v[116:117], v[16:31]
    v_mfma_f32_32x32x16_bf16 v[32:47], v[208:211], v[118:121], 0
    v_mfma_f32_32x32x16_bf16 v[32:47], v[212:215], v[122:125], v[32:47]
    v_mfma_f32_32x32x8bf16_1k v[32:47], v[216:217], v[126:127], v[32:47]
    s_nop 8
    v_cndmask_b32 v10, v28, v24, s[64:65]
    v_add_f32 v10, 897988541, v10
    v_rcp_f32 v10, v10
    v_lshrrev_b32 v13, 1, v6
    v_mov_b32 v11, v10
    v_pk_mul_f32 v[16:17], v[16:17], v[10:11]
    v_pk_mul_f32 v[18:19], v[18:19], v[10:11]
    v_pk_mul_f32 v[20:21], v[20:21], v[10:11]
    v_pk_mul_f32 v[22:23], v[22:23], v[10:11]
    v_pk_mul_f32 v[24:25], v[24:25], v[10:11]
    v_pk_mul_f32 v[26:27], v[26:27], v[10:11]
    v_cvt_pk_bf16_f32 v80, v16, v17
    v_cvt_pk_bf16_f32 v81, v18, v19
    v_cvt_pk_bf16_f32 v82, v20, v21
    v_cvt_pk_bf16_f32 v83, v22, v23
    v_cvt_pk_bf16_f32 v84, v24, v25
    v_cvt_pk_bf16_f32 v85, v26, v27
    buffer_store_dwordx4 v[80:83], v6, s[20:23], s54 offen sc1
    s_mov_b64 exec, s[60:61]
    buffer_store_dwordx2 v[84:85], v13, s[20:23], s57 offen sc1
    s_mov_b64 exec, -1
    v_cndmask_b32 v10, v44, v40, s[64:65]
    v_add_f32 v10, 897988541, v10
    v_rcp_f32 v10, v10
    v_lshrrev_b32 v13, 1, v6
    v_mov_b32 v11, v10
    v_pk_mul_f32 v[32:33], v[32:33], v[10:11]
    v_pk_mul_f32 v[34:35], v[34:35], v[10:11]
    v_pk_mul_f32 v[36:37], v[36:37], v[10:11]
    v_pk_mul_f32 v[38:39], v[38:39], v[10:11]
    v_pk_mul_f32 v[40:41], v[40:41], v[10:11]
    v_pk_mul_f32 v[42:43], v[42:43], v[10:11]
    v_cvt_pk_bf16_f32 v88, v32, v33
    v_cvt_pk_bf16_f32 v89, v34, v35
    v_cvt_pk_bf16_f32 v90, v36, v37
    v_cvt_pk_bf16_f32 v91, v38, v39
    v_cvt_pk_bf16_f32 v92, v40, v41
    v_cvt_pk_bf16_f32 v93, v42, v43
    buffer_store_dwordx4 v[88:91], v6, s[20:23], s55 offen sc1
    s_mov_b64 exec, s[60:61]
    buffer_store_dwordx2 v[92:93], v13, s[20:23], s58 offen sc1
    s_mov_b64 exec, -1
    s_sub_u32 s48, 1, s34
    s_lshl_b32 s48, s48, 3
    s_add_u32 s48, s48, s29
    s_lshl_b32 s48, s48, 2
    s_add_u32 s48, s48, s35
    s_lshl_b32 s48, s48, 5
    s_add_u32 s48, s48, s28
    s_lshl_b32 s48, s48, 2
    s_add_u32 s48, s48, 22609920
    v_mov_b32 v10, s91
    v_mov_b32 v11, s48
    s_waitcnt vmcnt(0)
    s_mov_b64 exec, 0x1
    buffer_store_dword v10, v11, s[96:99], 0 offen sc1
    s_mov_b64 exec, -1
    s_setprio 0
    s_branch K3_ENTRY
K2_BT:
    ds_read_b32 v10, v9
    s_waitcnt lgkmcnt(0)
    v_readfirstlane_b32 s49, v10
    s_nop 0
    s_cmp_eq_u32 s49, 0
    s_cbranch_scc1 K2_BT
    ds_read_b128 v[16:19], v7 offset:0
    ds_read_b128 v[20:23], v7 offset:1024
    ds_read_b128 v[24:27], v7 offset:2048
    ds_read_b128 v[28:31], v7 offset:3072
    ds_read_b128 v[32:35], v7 offset:4096
    ds_read_b128 v[36:39], v7 offset:5120
    ds_read_b128 v[40:43], v7 offset:6144
    ds_read_b128 v[44:47], v7 offset:7168
    s_waitcnt lgkmcnt(4)
    v_pk_add_f32 v[48:49], v[48:49], v[16:17]
    v_pk_add_f32 v[50:51], v[50:51], v[18:19]
    v_pk_add_f32 v[52:53], v[52:53], v[20:21]
    v_pk_add_f32 v[54:55], v[54:55], v[22:23]
    v_pk_add_f32 v[56:57], v[56:57], v[24:25]
    v_pk_add_f32 v[58:59], v[58:59], v[26:27]
    v_pk_add_f32 v[60:61], v[60:61], v[28:29]
    v_cndmask_b32 v10, v60, v56, s[64:65]
    v_mov_b32 v11, 1568669696
    v_cmp_nlt_f32 vcc, v10, v11
    s_cbranch_vccnz K2_FB0
K2_FIN0:
    v_rcp_f32 v10, v10
    v_lshrrev_b32 v13, 1, v6
    v_mov_b32 v11, v10
    v_pk_mul_f32 v[48:49], v[48:49], v[10:11]
    v_pk_mul_f32 v[50:51], v[50:51], v[10:11]
    v_pk_mul_f32 v[52:53], v[52:53], v[10:11]
    v_pk_mul_f32 v[54:55], v[54:55], v[10:11]
    v_pk_mul_f32 v[56:57], v[56:57], v[10:11]
    v_pk_mul_f32 v[58:59], v[58:59], v[10:11]
    v_cvt_pk_bf16_f32 v80, v48, v49
    v_cvt_pk_bf16_f32 v81, v50, v51
    v_cvt_pk_bf16_f32 v82, v52, v53
    v_cvt_pk_bf16_f32 v83, v54, v55
    v_cvt_pk_bf16_f32 v84, v56, v57
    v_cvt_pk_bf16_f32 v85, v58, v59
    buffer_store_dwordx4 v[80:83], v6, s[20:23], s54 offen sc1
    s_mov_b64 exec, s[60:61]
    buffer_store_dwordx2 v[84:85], v13, s[20:23], s57 offen sc1
    s_mov_b64 exec, -1
    s_waitcnt lgkmcnt(0)
    v_pk_add_f32 v[64:65], v[64:65], v[32:33]
    v_pk_add_f32 v[66:67], v[66:67], v[34:35]
    v_pk_add_f32 v[68:69], v[68:69], v[36:37]
    v_pk_add_f32 v[70:71], v[70:71], v[38:39]
    v_pk_add_f32 v[72:73], v[72:73], v[40:41]
    v_pk_add_f32 v[74:75], v[74:75], v[42:43]
    v_pk_add_f32 v[76:77], v[76:77], v[44:45]
    v_cndmask_b32 v10, v76, v72, s[64:65]
    v_mov_b32 v11, 1568669696
    v_cmp_nlt_f32 vcc, v10, v11
    s_cbranch_vccnz K2_FB1
K2_FIN1:
    v_rcp_f32 v10, v10
    v_lshrrev_b32 v13, 1, v6
    v_mov_b32 v11, v10
    v_pk_mul_f32 v[64:65], v[64:65], v[10:11]
    v_pk_mul_f32 v[66:67], v[66:67], v[10:11]
    v_pk_mul_f32 v[68:69], v[68:69], v[10:11]
    v_pk_mul_f32 v[70:71], v[70:71], v[10:11]
    v_pk_mul_f32 v[72:73], v[72:73], v[10:11]
    v_pk_mul_f32 v[74:75], v[74:75], v[10:11]
    v_cvt_pk_bf16_f32 v88, v64, v65
    v_cvt_pk_bf16_f32 v89, v66, v67
    v_cvt_pk_bf16_f32 v90, v68, v69
    v_cvt_pk_bf16_f32 v91, v70, v71
    v_cvt_pk_bf16_f32 v92, v72, v73
    v_cvt_pk_bf16_f32 v93, v74, v75
    buffer_store_dwordx4 v[88:91], v6, s[20:23], s55 offen sc1
    s_mov_b64 exec, s[60:61]
    buffer_store_dwordx2 v[92:93], v13, s[20:23], s58 offen sc1
    s_mov_b64 exec, -1
    s_sub_u32 s48, 1, s34
    s_lshl_b32 s48, s48, 3
    s_add_u32 s48, s48, s29
    s_lshl_b32 s48, s48, 2
    s_add_u32 s48, s48, s35
    s_lshl_b32 s48, s48, 5
    s_add_u32 s48, s48, s28
    s_lshl_b32 s48, s48, 2
    s_add_u32 s48, s48, 22609920
    v_mov_b32 v10, s91
    v_mov_b32 v11, s48
    s_waitcnt vmcnt(0)
    s_mov_b64 exec, 0x1
    buffer_store_dword v10, v11, s[96:99], 0 offen sc1
    s_mov_b64 exec, -1
    s_setprio 0
    s_branch K3_ENTRY
K2_END:
    s_endpgm
K2_FB0:
    s_waitcnt vmcnt(0)
    s_mov_b32 s47, s46
    s_mov_b32 s67, -1
    s_mov_b32 s53, 0
    v_mov_b32 v12, 0xff7fffff
    v_cndmask_b32 v100, v100, 0, s[64:65]
    v_mov_b32 v48, 0
    v_mov_b32 v49, 0
    v_mov_b32 v50, 0
    v_mov_b32 v51, 0
    v_mov_b32 v52, 0
    v_mov_b32 v53, 0
    v_mov_b32 v54, 0
    v_mov_b32 v55, 0
    v_mov_b32 v56, 0
    v_mov_b32 v57, 0
    v_mov_b32 v58, 0
    v_mov_b32 v59, 0
    v_mov_b32 v60, 0
    v_mov_b32 v61, 0
    v_mov_b32 v62, 0
    v_mov_b32 v63, 0
K2_FL0:
    s_mov_b64 exec, s[60:61]
    buffer_load_dwordx2 v[112:113], v4, s[20:23], s47 offen
    s_mov_b64 exec, s[62:63]
    buffer_load_dwordx4 v[114:117], v5, s[20:23], s47 offen
    buffer_load_dwordx4 v[118:121], v5, s[20:23], s47 offen offset:640
    s_mov_b64 exec, -1
    buffer_load_dwordx4 v[108:111], v3, s[20:23], s47 offen
    s_add_u32 s47, s47, 5120
    s_cmp_eq_u32 s47, s67
    s_cselect_b32 s47, s66, s47
    s_waitcnt vmcnt(0)
    v_mfma_f32_32x32x16_bf16 v[16:31], v[108:111], v[96:99], 0
    v_mfma_f32_32x32x8bf16_1k v[16:31], v[112:113], v[100:101], v[16:31]
    s_nop 11
    v_max3_f32 v10, v16, v17, v12
    v_max3_f32 v10, v10, v18, v19
    v_max3_f32 v10, v10, v20, v21
    v_max3_f32 v10, v10, v22, v23
    v_max3_f32 v10, v10, v24, v25
    v_max3_f32 v10, v10, v26, v27
    v_max3_f32 v10, v10, v28, v29
    v_max3_f32 v10, v10, v30, v31
    v_mov_b32 v14, v10
    s_nop 1
    v_permlane32_swap_b32 v14, v10
    v_max_f32 v10, v10, v14
    v_sub_f32 v12, v12, v10
    v_exp_f32 v14, v12
    v_mov_b32 v12, v10
    v_sub_f32 v16, v16, v10
    v_mul_f32 v48, v48, v14
    v_sub_f32 v17, v17, v10
    v_mul_f32 v49, v49, v14
    v_sub_f32 v18, v18, v10
    v_mul_f32 v50, v50, v14
    v_sub_f32 v19, v19, v10
    v_mul_f32 v51, v51, v14
    v_sub_f32 v20, v20, v10
    v_mul_f32 v52, v52, v14
    v_sub_f32 v21, v21, v10
    v_mul_f32 v53, v53, v14
    v_sub_f32 v22, v22, v10
    v_mul_f32 v54, v54, v14
    v_sub_f32 v23, v23, v10
    v_mul_f32 v55, v55, v14
    v_sub_f32 v24, v24, v10
    v_mul_f32 v56, v56, v14
    v_sub_f32 v25, v25, v10
    v_mul_f32 v57, v57, v14
    v_sub_f32 v26, v26, v10
    v_mul_f32 v58, v58, v14
    v_sub_f32 v27, v27, v10
    v_mul_f32 v59, v59, v14
    v_sub_f32 v28, v28, v10
    v_mul_f32 v60, v60, v14
    v_sub_f32 v29, v29, v10
    v_mul_f32 v61, v61, v14
    v_sub_f32 v30, v30, v10
    v_mul_f32 v62, v62, v14
    v_sub_f32 v31, v31, v10
    v_mul_f32 v63, v63, v14
    v_exp_f32 v16, v16
    v_exp_f32 v17, v17
    v_exp_f32 v18, v18
    v_exp_f32 v19, v19
    v_exp_f32 v20, v20
    v_exp_f32 v21, v21
    v_exp_f32 v22, v22
    v_exp_f32 v23, v23
    v_exp_f32 v24, v24
    v_exp_f32 v25, v25
    v_exp_f32 v26, v26
    v_exp_f32 v27, v27
    v_exp_f32 v28, v28
    v_exp_f32 v29, v29
    v_exp_f32 v30, v30
    v_exp_f32 v31, v31
    v_cvt_pk_bf16_f32 v88, v16, v17
    v_cvt_pk_bf16_f32 v89, v18, v19
    v_cvt_pk_bf16_f32 v90, v20, v21
    v_cvt_pk_bf16_f32 v91, v22, v23
    v_cvt_pk_bf16_f32 v92, v24, v25
    v_cvt_pk_bf16_f32 v93, v26, v27
    v_cvt_pk_bf16_f32 v94, v28, v29
    v_cvt_pk_bf16_f32 v95, v30, v31
    v_mfma_f32_32x32x16_bf16 v[48:63], v[114:117], v[88:91], v[48:63]
    s_nop 0
    v_mfma_f32_32x32x16_bf16 v[48:63], v[118:121], v[92:95], v[48:63]
    s_nop 15
    s_add_u32 s53, s53, 1
    s_cmp_lt_u32 s53, 64
    s_cbranch_scc1 K2_FL0
    v_cndmask_b32 v10, v60, v56, s[64:65]
    s_branch K2_FIN0
K2_FB1:
    s_waitcnt vmcnt(0)
    s_mov_b32 s47, s46
    s_mov_b32 s67, -1
    s_mov_b32 s53, 0
    v_mov_b32 v12, 0xff7fffff
    v_cndmask_b32 v106, v106, 0, s[64:65]
    v_mov_b32 v64, 0
    v_mov_b32 v65, 0
    v_mov_b32 v66, 0
    v_mov_b32 v67, 0
    v_mov_b32 v68, 0
    v_mov_b32 v69, 0
    v_mov_b32 v70, 0
    v_mov_b32 v71, 0
    v_mov_b32 v72, 0
    v_mov_b32 v73, 0
    v_mov_b32 v74, 0
    v_mov_b32 v75, 0
    v_mov_b32 v76, 0
    v_mov_b32 v77, 0
    v_mov_b32 v78, 0
    v_mov_b32 v79, 0
K2_FL1:
    s_mov_b64 exec, s[60:61]
    buffer_load_dwordx2 v[112:113], v4, s[20:23], s47 offen
    s_mov_b64 exec, s[62:63]
    buffer_load_dwordx4 v[114:117], v5, s[20:23], s47 offen
    buffer_load_dwordx4 v[118:121], v5, s[20:23], s47 offen offset:640
    s_mov_b64 exec, -1
    buffer_load_dwordx4 v[108:111], v3, s[20:23], s47 offen
    s_add_u32 s47, s47, 5120
    s_cmp_eq_u32 s47, s67
    s_cselect_b32 s47, s66, s47
    s_waitcnt vmcnt(0)
    v_mfma_f32_32x32x16_bf16 v[16:31], v[108:111], v[102:105], 0
    v_mfma_f32_32x32x8bf16_1k v[16:31], v[112:113], v[106:107], v[16:31]
    s_nop 11
    v_max3_f32 v10, v16, v17, v12
    v_max3_f32 v10, v10, v18, v19
    v_max3_f32 v10, v10, v20, v21
    v_max3_f32 v10, v10, v22, v23
    v_max3_f32 v10, v10, v24, v25
    v_max3_f32 v10, v10, v26, v27
    v_max3_f32 v10, v10, v28, v29
    v_max3_f32 v10, v10, v30, v31
    v_mov_b32 v14, v10
    s_nop 1
    v_permlane32_swap_b32 v14, v10
    v_max_f32 v10, v10, v14
    v_sub_f32 v12, v12, v10
    v_exp_f32 v14, v12
    v_mov_b32 v12, v10
    v_sub_f32 v16, v16, v10
    v_mul_f32 v64, v64, v14
    v_sub_f32 v17, v17, v10
    v_mul_f32 v65, v65, v14
    v_sub_f32 v18, v18, v10
    v_mul_f32 v66, v66, v14
    v_sub_f32 v19, v19, v10
    v_mul_f32 v67, v67, v14
    v_sub_f32 v20, v20, v10
    v_mul_f32 v68, v68, v14
    v_sub_f32 v21, v21, v10
    v_mul_f32 v69, v69, v14
    v_sub_f32 v22, v22, v10
    v_mul_f32 v70, v70, v14
    v_sub_f32 v23, v23, v10
    v_mul_f32 v71, v71, v14
    v_sub_f32 v24, v24, v10
    v_mul_f32 v72, v72, v14
    v_sub_f32 v25, v25, v10
    v_mul_f32 v73, v73, v14
    v_sub_f32 v26, v26, v10
    v_mul_f32 v74, v74, v14
    v_sub_f32 v27, v27, v10
    v_mul_f32 v75, v75, v14
    v_sub_f32 v28, v28, v10
    v_mul_f32 v76, v76, v14
    v_sub_f32 v29, v29, v10
    v_mul_f32 v77, v77, v14
    v_sub_f32 v30, v30, v10
    v_mul_f32 v78, v78, v14
    v_sub_f32 v31, v31, v10
    v_mul_f32 v79, v79, v14
    v_exp_f32 v16, v16
    v_exp_f32 v17, v17
    v_exp_f32 v18, v18
    v_exp_f32 v19, v19
    v_exp_f32 v20, v20
    v_exp_f32 v21, v21
    v_exp_f32 v22, v22
    v_exp_f32 v23, v23
    v_exp_f32 v24, v24
    v_exp_f32 v25, v25
    v_exp_f32 v26, v26
    v_exp_f32 v27, v27
    v_exp_f32 v28, v28
    v_exp_f32 v29, v29
    v_exp_f32 v30, v30
    v_exp_f32 v31, v31
    v_cvt_pk_bf16_f32 v88, v16, v17
    v_cvt_pk_bf16_f32 v89, v18, v19
    v_cvt_pk_bf16_f32 v90, v20, v21
    v_cvt_pk_bf16_f32 v91, v22, v23
    v_cvt_pk_bf16_f32 v92, v24, v25
    v_cvt_pk_bf16_f32 v93, v26, v27
    v_cvt_pk_bf16_f32 v94, v28, v29
    v_cvt_pk_bf16_f32 v95, v30, v31
    v_mfma_f32_32x32x16_bf16 v[64:79], v[114:117], v[88:91], v[64:79]
    s_nop 0
    v_mfma_f32_32x32x16_bf16 v[64:79], v[118:121], v[92:95], v[64:79]
    s_nop 15
    s_add_u32 s53, s53, 1
    s_cmp_lt_u32 s53, 64
    s_cbranch_scc1 K2_FL1
    v_cndmask_b32 v10, v76, v72, s[64:65]
    s_branch K2_FIN1
K3_ENTRY:
    v_mbcnt_lo_u32_b32 v0, -1, 0
    v_mbcnt_hi_u32_b32 v0, -1, v0
    s_lshl_b32 s3, s90, 6
    v_add_u32 v0, s3, v0
    s_cmp_ge_u32 s2, 240
    s_cbranch_scc1 K3_END
    s_load_dwordx2 s[4:5], s[0:1], 16
    s_load_dwordx4 s[8:11], s[0:1], 48
    s_load_dwordx2 s[12:13], s[0:1], 72
    s_and_b32 s3, s2, 7
    s_lshr_b32 s14, s2, 3
    s_cmp_ge_u32 s14, 20
    s_cselect_b32 s28, 1, 0
    s_cselect_b32 s15, 20, 0
    s_sub_u32 s14, s14, s15
    s_sub_u32 s15, 2, s28
    s_lshr_b32 s30, s14, s15
    s_lshl_b32 s29, s30, s15
    s_sub_u32 s29, s14, s29
    s_add_u32 s15, s28, 1
    s_lshl_b32 s29, s29, s15
    s_lshl_b32 s3, s3, 3
    s_add_u32 s29, s29, s3
    v_lshrrev_b32 v1, 6, v0
    v_and_b32 v0, 63, v0
    v_readfirstlane_b32 s33, v1
    s_waitcnt lgkmcnt(0)
    s_cmp_eq_u32 s28, 0
    s_cselect_b32 s4, s4, s8
    s_cselect_b32 s5, s5, s9
    s_mov_b32 s16, s4
    s_mov_b32 s17, s5
    s_mov_b32 s18, 819200
    s_mov_b32 s19, 0x20000
    s_mov_b32 s20, s12
    s_mov_b32 s21, s13
    s_mov_b32 s22, 24117248
    s_mov_b32 s23, 0x20000
    s_mov_b32 s24, s10
    s_mov_b32 s25, s11
    s_mov_b32 s26, 5242880
    s_mov_b32 s27, 0x20000
    s_and_b32 s33, s33, 3
    s_mul_i32 s35, s33, 20
    v_lshrrev_b32 v2, 4, v0
    v_add_u32 v1, s35, v2
    v_mul_u32_u24 v1, 0x500, v1
    v_and_b32 v3, 15, v0
    v_lshlrev_b32 v2, 2, v2
    v_xor_b32 v3, v3, v2
    v_lshl_add_u32 v6, v3, 4, v1
    s_lshl_b32 s35, s30, 8
    v_add_u32 v6, s35, v6
    s_mul_i32 s42, s33, 0x1400
    s_mov_b32 s43, 0
    s_mov_b32 s38, 0
    s_cmp_lt_u32 s90, 4
    s_cselect_b32 s38, 3, 5
    s_cselect_b32 s35, 61440, 0
    s_cselect_b32 s43, 0, 512000
    s_add_u32 s42, s42, s35
    s_cmp_lt_u32 s90, 4
    s_cbranch_scc1 K3_LD
    s_barrier
K3_LD:
    s_mov_b32 m0, s42
    s_nop 0
    buffer_load_dwordx4 v6, s[16:19], s43 offen lds
    s_add_u32 s42, s42, 1024
    s_add_u32 s43, s43, 5120
    s_mov_b32 m0, s42
    s_nop 0
    buffer_load_dwordx4 v6, s[16:19], s43 offen lds
    s_add_u32 s42, s42, 1024
    s_add_u32 s43, s43, 5120
    s_mov_b32 m0, s42
    s_nop 0
    buffer_load_dwordx4 v6, s[16:19], s43 offen lds
    s_add_u32 s42, s42, 1024
    s_add_u32 s43, s43, 5120
    s_mov_b32 m0, s42
    s_nop 0
    buffer_load_dwordx4 v6, s[16:19], s43 offen lds
    s_add_u32 s42, s42, 1024
    s_add_u32 s43, s43, 5120
    s_mov_b32 m0, s42
    s_nop 0
    buffer_load_dwordx4 v6, s[16:19], s43 offen lds
    s_add_u32 s42, s42, 16384
    s_add_u32 s43, s43, 81920
    s_add_u32 s38, s38, 1
    s_cmp_lt_u32 s38, 8
    s_cbranch_scc1 K3_LD
    s_cmp_lt_u32 s90, 4
    s_cbranch_scc1 K3_COMP
    s_waitcnt vmcnt(0)
    s_barrier
    s_endpgm
K3_COMP:
    v_and_b32 v1, 31, v0
    v_lshrrev_b32 v2, 5, v0
    s_and_b32 s34, s33, 1
    s_and_b32 s41, s33, 2
    s_cmp_eq_u32 s28, 0
    s_cselect_b32 s34, s34, s33
    s_cselect_b32 s41, s41, 0
    s_add_u32 s34, s34, s29
    s_lshl_b32 s35, s28, 6
    s_add_u32 s35, s35, s34
    s_mul_i32 s35, s35, 0xa000
    s_add_u32 s35, s35, 15728640
    s_add_u32 s36, s35, 0x8000
    v_lshlrev_b32 v3, 4, v0
    v_lshlrev_b32 v192, 3, v1
    v_lshl_add_u32 v192, v2, 9, v192
    s_lshl_b32 s39, s28, 5
    s_lshr_b32 s40, s34, 1
    s_add_u32 s39, s39, s40
    s_lshl_b32 s39, s39, 7
    s_add_u32 s39, s39, 22609920
    v_bfe_u32 v4, v0, 2, 2
    v_bfe_u32 v5, v0, 4, 1
    v_lshlrev_b32 v6, 5, v5
    v_and_b32 v5, 3, v0
    v_lshl_add_u32 v6, v5, 3, v6
    v_lshl_add_u32 v6, v4, 8, v6
    s_add_u32 s40, s41, 0
    v_xor_b32 v5, s40, v4
    v_lshl_add_u32 v5, v5, 6, v6
    v_lshl_add_u32 v8, v2, 11, v5
    v_mul_u32_u24 v7, 0x2800, v2
    v_add_u32 v12, v7, v5
    s_add_u32 s40, s41, 1
    v_xor_b32 v5, s40, v4
    v_lshl_add_u32 v5, v5, 6, v6
    v_lshl_add_u32 v9, v2, 11, v5
    v_mul_u32_u24 v7, 0x2800, v2
    v_add_u32 v13, v7, v5
    s_add_u32 s40, s41, 2
    v_xor_b32 v5, s40, v4
    v_lshl_add_u32 v5, v5, 6, v6
    v_lshl_add_u32 v10, v2, 11, v5
    v_mul_u32_u24 v7, 0x2800, v2
    v_add_u32 v14, v7, v5
    s_add_u32 s40, s41, 3
    v_xor_b32 v5, s40, v4
    v_lshl_add_u32 v5, v5, 6, v6
    v_lshl_add_u32 v11, v2, 11, v5
    v_mul_u32_u24 v7, 0x2800, v2
    v_add_u32 v15, v7, v5
    v_mov_b32 v48, 0
    v_mov_b32 v49, 0
    v_mov_b32 v50, 0
    v_mov_b32 v51, 0
    v_mov_b32 v52, 0
    v_mov_b32 v53, 0
    v_mov_b32 v54, 0
    v_mov_b32 v55, 0
    v_mov_b32 v56, 0
    v_mov_b32 v57, 0
    v_mov_b32 v58, 0
    v_mov_b32 v59, 0
    v_mov_b32 v60, 0
    v_mov_b32 v61, 0
    v_mov_b32 v62, 0
    v_mov_b32 v63, 0
    v_mov_b32 v64, 0
    v_mov_b32 v65, 0
    v_mov_b32 v66, 0
    v_mov_b32 v67, 0
    v_mov_b32 v68, 0
    v_mov_b32 v69, 0
    v_mov_b32 v70, 0
    v_mov_b32 v71, 0
    v_mov_b32 v72, 0
    v_mov_b32 v73, 0
    v_mov_b32 v74, 0
    v_mov_b32 v75, 0
    v_mov_b32 v76, 0
    v_mov_b32 v77, 0
    v_mov_b32 v78, 0
    v_mov_b32 v79, 0
    v_mov_b32 v80, 0
    v_mov_b32 v81, 0
    v_mov_b32 v82, 0
    v_mov_b32 v83, 0
    v_mov_b32 v84, 0
    v_mov_b32 v85, 0
    v_mov_b32 v86, 0
    v_mov_b32 v87, 0
    v_mov_b32 v88, 0
    v_mov_b32 v89, 0
    v_mov_b32 v90, 0
    v_mov_b32 v91, 0
    v_mov_b32 v92, 0
    v_mov_b32 v93, 0
    v_mov_b32 v94, 0
    v_mov_b32 v95, 0
    v_mov_b32 v96, 0
    v_mov_b32 v97, 0
    v_mov_b32 v98, 0
    v_mov_b32 v99, 0
    v_mov_b32 v100, 0
    v_mov_b32 v101, 0
    v_mov_b32 v102, 0
    v_mov_b32 v103, 0
    v_mov_b32 v104, 0
    v_mov_b32 v105, 0
    v_mov_b32 v106, 0
    v_mov_b32 v107, 0
    v_mov_b32 v108, 0
    v_mov_b32 v109, 0
    v_mov_b32 v110, 0
    v_mov_b32 v111, 0
    s_lshl_b32 s34, s34, 5
    v_add_u32 v4, s34, v1
    v_mul_u32_u24 v4, 0xa00, v4
    s_mul_i32 s37, s28, 0x500
    s_lshl_b32 s38, s30, 8
    s_add_u32 s37, s37, s38
    s_lshl_b32 s38, s41, 6
    s_add_u32 s37, s37, s38
    v_lshl_add_u32 v4, v2, 4, v4
    v_add_u32 v4, s37, v4
    s_cmp_eq_u32 s28, 0
    s_cbranch_scc1 K3_A
    v_add_u32 v8, 61440, v8
    v_add_u32 v9, 61440, v9
    v_add_u32 v10, 61440, v10
    v_add_u32 v11, 61440, v11
    v_add_u32 v12, 61440, v12
    v_add_u32 v13, 61440, v13
    v_add_u32 v14, 61440, v14
    v_add_u32 v15, 61440, v15
    v_lshlrev_b32 v5, 2, v1
    v_add_u32 v5, s39, v5
    s_waitcnt vmcnt(0)
    v_mov_b32 v6, 58376
    v_mov_b32 v7, 1
    s_mov_b64 exec, 1
    ds_add_u32 v6, v7
K3_SP:
    ds_read_b32 v7, v6
    s_waitcnt lgkmcnt(0)
    v_readfirstlane_b32 s40, v7
    s_nop 0
    s_cmp_lt_u32 s40, 4
    s_cbranch_scc1 K3_SP
    s_mov_b64 exec, -1
    s_mov_b32 s89, 0
K3_Q4:
    buffer_load_dword v6, v5, s[96:99], 0 offen sc1
    s_add_u32 s89, s89, 1
    s_waitcnt vmcnt(0)
    v_xor_b32 v6, s91, v6
    v_cmp_ne_u32 vcc, 0, v6
    s_cbranch_vccz K3_Q4X
    s_sleep 2
    s_cmp_lt_u32 s89, 0x8000
    s_cbranch_scc1 K3_Q4
K3_Q4X:
    buffer_load_dwordx4 v[112:115], v3, s[20:23], s35 offen offset:0 sc1
    buffer_load_dwordx4 v[116:119], v3, s[20:23], s35 offen offset:1024 sc1
    buffer_load_dwordx4 v[120:123], v3, s[20:23], s35 offen offset:2048 sc1
    buffer_load_dwordx4 v[124:127], v3, s[20:23], s35 offen offset:3072 sc1
    buffer_load_dwordx2 v[128:129], v192, s[20:23], s36 offen sc1
    buffer_load_dwordx2 v[130:131], v192, s[20:23], s36 offen offset:256 sc1
    s_add_u32 s35, s35, 0x1000
    s_add_u32 s36, s36, 0x400
    buffer_load_dwordx4 v[132:135], v3, s[20:23], s35 offen offset:0 sc1
    buffer_load_dwordx4 v[136:139], v3, s[20:23], s35 offen offset:1024 sc1
    buffer_load_dwordx4 v[140:143], v3, s[20:23], s35 offen offset:2048 sc1
    buffer_load_dwordx4 v[144:147], v3, s[20:23], s35 offen offset:3072 sc1
    buffer_load_dwordx2 v[148:149], v192, s[20:23], s36 offen sc1
    buffer_load_dwordx2 v[150:151], v192, s[20:23], s36 offen offset:256 sc1
    s_add_u32 s35, s35, 0x1000
    s_add_u32 s36, s36, 0x400
    buffer_load_dwordx4 v[152:155], v3, s[20:23], s35 offen offset:0 sc1
    buffer_load_dwordx4 v[156:159], v3, s[20:23], s35 offen offset:1024 sc1
    buffer_load_dwordx4 v[160:163], v3, s[20:23], s35 offen offset:2048 sc1
    buffer_load_dwordx4 v[164:167], v3, s[20:23], s35 offen offset:3072 sc1
    buffer_load_dwordx2 v[168:169], v192, s[20:23], s36 offen sc1
    buffer_load_dwordx2 v[170:171], v192, s[20:23], s36 offen offset:256 sc1
    s_add_u32 s35, s35, 0x1000
    s_add_u32 s36, s36, 0x400
    buffer_load_dwordx4 v[172:175], v3, s[20:23], s35 offen offset:0 sc1
    buffer_load_dwordx4 v[176:179], v3, s[20:23], s35 offen offset:1024 sc1
    buffer_load_dwordx4 v[180:183], v3, s[20:23], s35 offen offset:2048 sc1
    buffer_load_dwordx4 v[184:187], v3, s[20:23], s35 offen offset:3072 sc1
    buffer_load_dwordx2 v[188:189], v192, s[20:23], s36 offen sc1
    buffer_load_dwordx2 v[190:191], v192, s[20:23], s36 offen offset:256 sc1
    s_add_u32 s35, s35, 0x1000
    s_add_u32 s36, s36, 0x400
    ds_read_b64_tr_b16 v[16:17], v8 offset:0
    ds_read_b64_tr_b16 v[18:19], v8 offset:1024
    ds_read_b64_tr_b16 v[20:21], v9 offset:0
    ds_read_b64_tr_b16 v[22:23], v9 offset:1024
    ds_read_b64_tr_b16 v[24:25], v10 offset:0
    ds_read_b64_tr_b16 v[26:27], v10 offset:1024
    ds_read_b64_tr_b16 v[28:29], v11 offset:0
    ds_read_b64_tr_b16 v[30:31], v11 offset:1024
    s_waitcnt vmcnt(18) lgkmcnt(0)
    v_mfma_f32_32x32x16_bf16 v[48:63], v[16:19], v[112:115], v[48:63]
    ds_read_b64_tr_b16 v[32:33], v8 offset:5120
    ds_read_b64_tr_b16 v[34:35], v8 offset:6144
    ds_read_b64_tr_b16 v[36:37], v9 offset:5120
    v_mfma_f32_32x32x16_bf16 v[64:79], v[20:23], v[112:115], v[64:79]
    ds_read_b64_tr_b16 v[38:39], v9 offset:6144
    ds_read_b64_tr_b16 v[40:41], v10 offset:5120
    ds_read_b64_tr_b16 v[42:43], v10 offset:6144
    v_mfma_f32_32x32x16_bf16 v[80:95], v[24:27], v[112:115], v[80:95]
    ds_read_b64_tr_b16 v[44:45], v11 offset:5120
    ds_read_b64_tr_b16 v[46:47], v11 offset:6144
    v_mfma_f32_32x32x16_bf16 v[96:111], v[28:31], v[112:115], v[96:111]
    s_waitcnt lgkmcnt(0)
    v_mfma_f32_32x32x16_bf16 v[48:63], v[32:35], v[116:119], v[48:63]
    ds_read_b64_tr_b16 v[16:17], v8 offset:10240
    ds_read_b64_tr_b16 v[18:19], v8 offset:11264
    ds_read_b64_tr_b16 v[20:21], v9 offset:10240
    v_mfma_f32_32x32x16_bf16 v[64:79], v[36:39], v[116:119], v[64:79]
    ds_read_b64_tr_b16 v[22:23], v9 offset:11264
    ds_read_b64_tr_b16 v[24:25], v10 offset:10240
    ds_read_b64_tr_b16 v[26:27], v10 offset:11264
    v_mfma_f32_32x32x16_bf16 v[80:95], v[40:43], v[116:119], v[80:95]
    ds_read_b64_tr_b16 v[28:29], v11 offset:10240
    ds_read_b64_tr_b16 v[30:31], v11 offset:11264
    v_mfma_f32_32x32x16_bf16 v[96:111], v[44:47], v[116:119], v[96:111]
    s_waitcnt lgkmcnt(0)
    v_mfma_f32_32x32x16_bf16 v[48:63], v[16:19], v[120:123], v[48:63]
    ds_read_b64_tr_b16 v[32:33], v8 offset:15360
    ds_read_b64_tr_b16 v[34:35], v8 offset:16384
    ds_read_b64_tr_b16 v[36:37], v9 offset:15360
    v_mfma_f32_32x32x16_bf16 v[64:79], v[20:23], v[120:123], v[64:79]
    ds_read_b64_tr_b16 v[38:39], v9 offset:16384
    ds_read_b64_tr_b16 v[40:41], v10 offset:15360
    ds_read_b64_tr_b16 v[42:43], v10 offset:16384
    v_mfma_f32_32x32x16_bf16 v[80:95], v[24:27], v[120:123], v[80:95]
    ds_read_b64_tr_b16 v[44:45], v11 offset:15360
    ds_read_b64_tr_b16 v[46:47], v11 offset:16384
    v_mfma_f32_32x32x16_bf16 v[96:111], v[28:31], v[120:123], v[96:111]
    s_waitcnt lgkmcnt(0)
    v_mfma_f32_32x32x16_bf16 v[48:63], v[32:35], v[124:127], v[48:63]
    ds_read_b64_tr_b16 v[16:17], v12 offset:4096
    ds_read_b64_tr_b16 v[18:19], v12 offset:9216
    ds_read_b64_tr_b16 v[20:21], v13 offset:4096
    v_mfma_f32_32x32x16_bf16 v[64:79], v[36:39], v[124:127], v[64:79]
    ds_read_b64_tr_b16 v[22:23], v13 offset:9216
    ds_read_b64_tr_b16 v[24:25], v14 offset:4096
    ds_read_b64_tr_b16 v[26:27], v14 offset:9216
    v_mfma_f32_32x32x16_bf16 v[80:95], v[40:43], v[124:127], v[80:95]
    ds_read_b64_tr_b16 v[28:29], v15 offset:4096
    ds_read_b64_tr_b16 v[30:31], v15 offset:9216
    v_mfma_f32_32x32x16_bf16 v[96:111], v[44:47], v[124:127], v[96:111]
    s_waitcnt lgkmcnt(0)
    v_mfma_f32_32x32x16_bf16 v[48:63], v[16:19], v[128:131], v[48:63]
    ds_read_b64_tr_b16 v[32:33], v8 offset:20480
    ds_read_b64_tr_b16 v[34:35], v8 offset:21504
    ds_read_b64_tr_b16 v[36:37], v9 offset:20480
    v_mfma_f32_32x32x16_bf16 v[64:79], v[20:23], v[128:131], v[64:79]
    ds_read_b64_tr_b16 v[38:39], v9 offset:21504
    ds_read_b64_tr_b16 v[40:41], v10 offset:20480
    ds_read_b64_tr_b16 v[42:43], v10 offset:21504
    v_mfma_f32_32x32x16_bf16 v[80:95], v[24:27], v[128:131], v[80:95]
    ds_read_b64_tr_b16 v[44:45], v11 offset:20480
    ds_read_b64_tr_b16 v[46:47], v11 offset:21504
    v_mfma_f32_32x32x16_bf16 v[96:111], v[28:31], v[128:131], v[96:111]
    s_waitcnt vmcnt(12) lgkmcnt(0)
    buffer_load_dwordx4 v[112:115], v3, s[20:23], s35 offen offset:0 sc1
    buffer_load_dwordx4 v[116:119], v3, s[20:23], s35 offen offset:1024 sc1
    buffer_load_dwordx4 v[120:123], v3, s[20:23], s35 offen offset:2048 sc1
    buffer_load_dwordx4 v[124:127], v3, s[20:23], s35 offen offset:3072 sc1
    buffer_load_dwordx2 v[128:129], v192, s[20:23], s36 offen sc1
    buffer_load_dwordx2 v[130:131], v192, s[20:23], s36 offen offset:256 sc1
    s_add_u32 s35, s35, 0x1000
    s_add_u32 s36, s36, 0x400
    v_mfma_f32_32x32x16_bf16 v[48:63], v[32:35], v[132:135], v[48:63]
    ds_read_b64_tr_b16 v[16:17], v8 offset:25600
    ds_read_b64_tr_b16 v[18:19], v8 offset:26624
    ds_read_b64_tr_b16 v[20:21], v9 offset:25600
    v_mfma_f32_32x32x16_bf16 v[64:79], v[36:39], v[132:135], v[64:79]
    ds_read_b64_tr_b16 v[22:23], v9 offset:26624
    ds_read_b64_tr_b16 v[24:25], v10 offset:25600
    ds_read_b64_tr_b16 v[26:27], v10 offset:26624
    v_mfma_f32_32x32x16_bf16 v[80:95], v[40:43], v[132:135], v[80:95]
    ds_read_b64_tr_b16 v[28:29], v11 offset:25600
    ds_read_b64_tr_b16 v[30:31], v11 offset:26624
    v_mfma_f32_32x32x16_bf16 v[96:111], v[44:47], v[132:135], v[96:111]
    s_waitcnt lgkmcnt(0)
    v_mfma_f32_32x32x16_bf16 v[48:63], v[16:19], v[136:139], v[48:63]
    ds_read_b64_tr_b16 v[32:33], v8 offset:30720
    ds_read_b64_tr_b16 v[34:35], v8 offset:31744
    ds_read_b64_tr_b16 v[36:37], v9 offset:30720
    v_mfma_f32_32x32x16_bf16 v[64:79], v[20:23], v[136:139], v[64:79]
    ds_read_b64_tr_b16 v[38:39], v9 offset:31744
    ds_read_b64_tr_b16 v[40:41], v10 offset:30720
    ds_read_b64_tr_b16 v[42:43], v10 offset:31744
    v_mfma_f32_32x32x16_bf16 v[80:95], v[24:27], v[136:139], v[80:95]
    ds_read_b64_tr_b16 v[44:45], v11 offset:30720
    ds_read_b64_tr_b16 v[46:47], v11 offset:31744
    v_mfma_f32_32x32x16_bf16 v[96:111], v[28:31], v[136:139], v[96:111]
    s_waitcnt lgkmcnt(0)
    v_mfma_f32_32x32x16_bf16 v[48:63], v[32:35], v[140:143], v[48:63]
    ds_read_b64_tr_b16 v[16:17], v8 offset:35840
    ds_read_b64_tr_b16 v[18:19], v8 offset:36864
    ds_read_b64_tr_b16 v[20:21], v9 offset:35840
    v_mfma_f32_32x32x16_bf16 v[64:79], v[36:39], v[140:143], v[64:79]
    ds_read_b64_tr_b16 v[22:23], v9 offset:36864
    ds_read_b64_tr_b16 v[24:25], v10 offset:35840
    ds_read_b64_tr_b16 v[26:27], v10 offset:36864
    v_mfma_f32_32x32x16_bf16 v[80:95], v[40:43], v[140:143], v[80:95]
    ds_read_b64_tr_b16 v[28:29], v11 offset:35840
    ds_read_b64_tr_b16 v[30:31], v11 offset:36864
    v_mfma_f32_32x32x16_bf16 v[96:111], v[44:47], v[140:143], v[96:111]
    s_waitcnt lgkmcnt(0)
    v_mfma_f32_32x32x16_bf16 v[48:63], v[16:19], v[144:147], v[48:63]
    ds_read_b64_tr_b16 v[32:33], v12 offset:24576
    ds_read_b64_tr_b16 v[34:35], v12 offset:29696
    ds_read_b64_tr_b16 v[36:37], v13 offset:24576
    v_mfma_f32_32x32x16_bf16 v[64:79], v[20:23], v[144:147], v[64:79]
    ds_read_b64_tr_b16 v[38:39], v13 offset:29696
    ds_read_b64_tr_b16 v[40:41], v14 offset:24576
    ds_read_b64_tr_b16 v[42:43], v14 offset:29696
    v_mfma_f32_32x32x16_bf16 v[80:95], v[24:27], v[144:147], v[80:95]
    ds_read_b64_tr_b16 v[44:45], v15 offset:24576
    ds_read_b64_tr_b16 v[46:47], v15 offset:29696
    v_mfma_f32_32x32x16_bf16 v[96:111], v[28:31], v[144:147], v[96:111]
    s_waitcnt lgkmcnt(0)
    v_mfma_f32_32x32x16_bf16 v[48:63], v[32:35], v[148:151], v[48:63]
    ds_read_b64_tr_b16 v[16:17], v8 offset:40960
    ds_read_b64_tr_b16 v[18:19], v8 offset:41984
    ds_read_b64_tr_b16 v[20:21], v9 offset:40960
    v_mfma_f32_32x32x16_bf16 v[64:79], v[36:39], v[148:151], v[64:79]
    ds_read_b64_tr_b16 v[22:23], v9 offset:41984
    ds_read_b64_tr_b16 v[24:25], v10 offset:40960
    ds_read_b64_tr_b16 v[26:27], v10 offset:41984
    v_mfma_f32_32x32x16_bf16 v[80:95], v[40:43], v[148:151], v[80:95]
    ds_read_b64_tr_b16 v[28:29], v11 offset:40960
    ds_read_b64_tr_b16 v[30:31], v11 offset:41984
    v_mfma_f32_32x32x16_bf16 v[96:111], v[44:47], v[148:151], v[96:111]
    s_waitcnt vmcnt(12) lgkmcnt(0)
    buffer_load_dwordx4 v[132:135], v3, s[20:23], s35 offen offset:0 sc1
    buffer_load_dwordx4 v[136:139], v3, s[20:23], s35 offen offset:1024 sc1
    buffer_load_dwordx4 v[140:143], v3, s[20:23], s35 offen offset:2048 sc1
    buffer_load_dwordx4 v[144:147], v3, s[20:23], s35 offen offset:3072 sc1
    buffer_load_dwordx2 v[148:149], v192, s[20:23], s36 offen sc1
    buffer_load_dwordx2 v[150:151], v192, s[20:23], s36 offen offset:256 sc1
    s_add_u32 s35, s35, 0x1000
    s_add_u32 s36, s36, 0x400
    v_mfma_f32_32x32x16_bf16 v[48:63], v[16:19], v[152:155], v[48:63]
    ds_read_b64_tr_b16 v[32:33], v8 offset:46080
    ds_read_b64_tr_b16 v[34:35], v8 offset:47104
    ds_read_b64_tr_b16 v[36:37], v9 offset:46080
    v_mfma_f32_32x32x16_bf16 v[64:79], v[20:23], v[152:155], v[64:79]
    ds_read_b64_tr_b16 v[38:39], v9 offset:47104
    ds_read_b64_tr_b16 v[40:41], v10 offset:46080
    ds_read_b64_tr_b16 v[42:43], v10 offset:47104
    v_mfma_f32_32x32x16_bf16 v[80:95], v[24:27], v[152:155], v[80:95]
    ds_read_b64_tr_b16 v[44:45], v11 offset:46080
    ds_read_b64_tr_b16 v[46:47], v11 offset:47104
    v_mfma_f32_32x32x16_bf16 v[96:111], v[28:31], v[152:155], v[96:111]
    s_waitcnt lgkmcnt(0)
    v_mfma_f32_32x32x16_bf16 v[48:63], v[32:35], v[156:159], v[48:63]
    ds_read_b64_tr_b16 v[16:17], v8 offset:51200
    ds_read_b64_tr_b16 v[18:19], v8 offset:52224
    ds_read_b64_tr_b16 v[20:21], v9 offset:51200
    v_mfma_f32_32x32x16_bf16 v[64:79], v[36:39], v[156:159], v[64:79]
    ds_read_b64_tr_b16 v[22:23], v9 offset:52224
    ds_read_b64_tr_b16 v[24:25], v10 offset:51200
    ds_read_b64_tr_b16 v[26:27], v10 offset:52224
    v_mfma_f32_32x32x16_bf16 v[80:95], v[40:43], v[156:159], v[80:95]
    ds_read_b64_tr_b16 v[28:29], v11 offset:51200
    ds_read_b64_tr_b16 v[30:31], v11 offset:52224
    v_mfma_f32_32x32x16_bf16 v[96:111], v[44:47], v[156:159], v[96:111]
    s_waitcnt lgkmcnt(0)
    v_mfma_f32_32x32x16_bf16 v[48:63], v[16:19], v[160:163], v[48:63]
    ds_read_b64_tr_b16 v[32:33], v8 offset:56320
    ds_read_b64_tr_b16 v[34:35], v8 offset:57344
    ds_read_b64_tr_b16 v[36:37], v9 offset:56320
    v_mfma_f32_32x32x16_bf16 v[64:79], v[20:23], v[160:163], v[64:79]
    ds_read_b64_tr_b16 v[38:39], v9 offset:57344
    ds_read_b64_tr_b16 v[40:41], v10 offset:56320
    ds_read_b64_tr_b16 v[42:43], v10 offset:57344
    v_mfma_f32_32x32x16_bf16 v[80:95], v[24:27], v[160:163], v[80:95]
    ds_read_b64_tr_b16 v[44:45], v11 offset:56320
    ds_read_b64_tr_b16 v[46:47], v11 offset:57344
    v_mfma_f32_32x32x16_bf16 v[96:111], v[28:31], v[160:163], v[96:111]
    s_waitcnt lgkmcnt(0)
    v_mfma_f32_32x32x16_bf16 v[48:63], v[32:35], v[164:167], v[48:63]
    ds_read_b64_tr_b16 v[16:17], v12 offset:45056
    ds_read_b64_tr_b16 v[18:19], v12 offset:50176
    ds_read_b64_tr_b16 v[20:21], v13 offset:45056
    v_mfma_f32_32x32x16_bf16 v[64:79], v[36:39], v[164:167], v[64:79]
    ds_read_b64_tr_b16 v[22:23], v13 offset:50176
    ds_read_b64_tr_b16 v[24:25], v14 offset:45056
    ds_read_b64_tr_b16 v[26:27], v14 offset:50176
    v_mfma_f32_32x32x16_bf16 v[80:95], v[40:43], v[164:167], v[80:95]
    ds_read_b64_tr_b16 v[28:29], v15 offset:45056
    ds_read_b64_tr_b16 v[30:31], v15 offset:50176
    v_mfma_f32_32x32x16_bf16 v[96:111], v[44:47], v[164:167], v[96:111]
    s_waitcnt lgkmcnt(0)
    v_mfma_f32_32x32x16_bf16 v[48:63], v[16:19], v[168:171], v[48:63]
    v_add_u32 v8, 61440, v8
    v_add_u32 v9, 61440, v9
    v_add_u32 v10, 61440, v10
    v_add_u32 v11, 61440, v11
    v_add_u32 v12, 61440, v12
    v_add_u32 v13, 61440, v13
    v_add_u32 v14, 61440, v14
    v_add_u32 v15, 61440, v15
    ds_read_b64_tr_b16 v[32:33], v8 offset:0
    ds_read_b64_tr_b16 v[34:35], v8 offset:1024
    ds_read_b64_tr_b16 v[36:37], v9 offset:0
    v_mfma_f32_32x32x16_bf16 v[64:79], v[20:23], v[168:171], v[64:79]
    ds_read_b64_tr_b16 v[38:39], v9 offset:1024
    ds_read_b64_tr_b16 v[40:41], v10 offset:0
    ds_read_b64_tr_b16 v[42:43], v10 offset:1024
    v_mfma_f32_32x32x16_bf16 v[80:95], v[24:27], v[168:171], v[80:95]
    ds_read_b64_tr_b16 v[44:45], v11 offset:0
    ds_read_b64_tr_b16 v[46:47], v11 offset:1024
    v_mfma_f32_32x32x16_bf16 v[96:111], v[28:31], v[168:171], v[96:111]
    s_waitcnt vmcnt(12) lgkmcnt(0)
    buffer_load_dwordx4 v[152:155], v3, s[20:23], s35 offen offset:0 sc1
    buffer_load_dwordx4 v[156:159], v3, s[20:23], s35 offen offset:1024 sc1
    buffer_load_dwordx4 v[160:163], v3, s[20:23], s35 offen offset:2048 sc1
    buffer_load_dwordx4 v[164:167], v3, s[20:23], s35 offen offset:3072 sc1
    buffer_load_dwordx2 v[168:169], v192, s[20:23], s36 offen sc1
    buffer_load_dwordx2 v[170:171], v192, s[20:23], s36 offen offset:256 sc1
    s_add_u32 s35, s35, 0x1000
    s_add_u32 s36, s36, 0x400
    v_mfma_f32_32x32x16_bf16 v[48:63], v[32:35], v[172:175], v[48:63]
    ds_read_b64_tr_b16 v[16:17], v8 offset:5120
    ds_read_b64_tr_b16 v[18:19], v8 offset:6144
    ds_read_b64_tr_b16 v[20:21], v9 offset:5120
    v_mfma_f32_32x32x16_bf16 v[64:79], v[36:39], v[172:175], v[64:79]
    ds_read_b64_tr_b16 v[22:23], v9 offset:6144
    ds_read_b64_tr_b16 v[24:25], v10 offset:5120
    ds_read_b64_tr_b16 v[26:27], v10 offset:6144
    v_mfma_f32_32x32x16_bf16 v[80:95], v[40:43], v[172:175], v[80:95]
    ds_read_b64_tr_b16 v[28:29], v11 offset:5120
    ds_read_b64_tr_b16 v[30:31], v11 offset:6144
    v_mfma_f32_32x32x16_bf16 v[96:111], v[44:47], v[172:175], v[96:111]
    s_waitcnt lgkmcnt(0)
    v_mfma_f32_32x32x16_bf16 v[48:63], v[16:19], v[176:179], v[48:63]
    ds_read_b64_tr_b16 v[32:33], v8 offset:10240
    ds_read_b64_tr_b16 v[34:35], v8 offset:11264
    ds_read_b64_tr_b16 v[36:37], v9 offset:10240
    v_mfma_f32_32x32x16_bf16 v[64:79], v[20:23], v[176:179], v[64:79]
    ds_read_b64_tr_b16 v[38:39], v9 offset:11264
    ds_read_b64_tr_b16 v[40:41], v10 offset:10240
    ds_read_b64_tr_b16 v[42:43], v10 offset:11264
    v_mfma_f32_32x32x16_bf16 v[80:95], v[24:27], v[176:179], v[80:95]
    ds_read_b64_tr_b16 v[44:45], v11 offset:10240
    ds_read_b64_tr_b16 v[46:47], v11 offset:11264
    v_mfma_f32_32x32x16_bf16 v[96:111], v[28:31], v[176:179], v[96:111]
    s_waitcnt lgkmcnt(0)
    v_mfma_f32_32x32x16_bf16 v[48:63], v[32:35], v[180:183], v[48:63]
    ds_read_b64_tr_b16 v[16:17], v8 offset:15360
    ds_read_b64_tr_b16 v[18:19], v8 offset:16384
    ds_read_b64_tr_b16 v[20:21], v9 offset:15360
    v_mfma_f32_32x32x16_bf16 v[64:79], v[36:39], v[180:183], v[64:79]
    ds_read_b64_tr_b16 v[22:23], v9 offset:16384
    ds_read_b64_tr_b16 v[24:25], v10 offset:15360
    ds_read_b64_tr_b16 v[26:27], v10 offset:16384
    v_mfma_f32_32x32x16_bf16 v[80:95], v[40:43], v[180:183], v[80:95]
    ds_read_b64_tr_b16 v[28:29], v11 offset:15360
    ds_read_b64_tr_b16 v[30:31], v11 offset:16384
    v_mfma_f32_32x32x16_bf16 v[96:111], v[44:47], v[180:183], v[96:111]
    s_waitcnt lgkmcnt(0)
    v_mfma_f32_32x32x16_bf16 v[48:63], v[16:19], v[184:187], v[48:63]
    ds_read_b64_tr_b16 v[32:33], v12 offset:4096
    ds_read_b64_tr_b16 v[34:35], v12 offset:9216
    ds_read_b64_tr_b16 v[36:37], v13 offset:4096
    v_mfma_f32_32x32x16_bf16 v[64:79], v[20:23], v[184:187], v[64:79]
    ds_read_b64_tr_b16 v[38:39], v13 offset:9216
    ds_read_b64_tr_b16 v[40:41], v14 offset:4096
    ds_read_b64_tr_b16 v[42:43], v14 offset:9216
    v_mfma_f32_32x32x16_bf16 v[80:95], v[24:27], v[184:187], v[80:95]
    ds_read_b64_tr_b16 v[44:45], v15 offset:4096
    ds_read_b64_tr_b16 v[46:47], v15 offset:9216
    v_mfma_f32_32x32x16_bf16 v[96:111], v[28:31], v[184:187], v[96:111]
    s_waitcnt lgkmcnt(0)
    v_mfma_f32_32x32x16_bf16 v[48:63], v[32:35], v[188:191], v[48:63]
    ds_read_b64_tr_b16 v[16:17], v8 offset:20480
    ds_read_b64_tr_b16 v[18:19], v8 offset:21504
    ds_read_b64_tr_b16 v[20:21], v9 offset:20480
    v_mfma_f32_32x32x16_bf16 v[64:79], v[36:39], v[188:191], v[64:79]
    ds_read_b64_tr_b16 v[22:23], v9 offset:21504
    ds_read_b64_tr_b16 v[24:25], v10 offset:20480
    ds_read_b64_tr_b16 v[26:27], v10 offset:21504
    v_mfma_f32_32x32x16_bf16 v[80:95], v[40:43], v[188:191], v[80:95]
    ds_read_b64_tr_b16 v[28:29], v11 offset:20480
    ds_read_b64_tr_b16 v[30:31], v11 offset:21504
    v_mfma_f32_32x32x16_bf16 v[96:111], v[44:47], v[188:191], v[96:111]
    s_waitcnt vmcnt(12) lgkmcnt(0)
    buffer_load_dwordx4 v[172:175], v3, s[20:23], s35 offen offset:0 sc1
    buffer_load_dwordx4 v[176:179], v3, s[20:23], s35 offen offset:1024 sc1
    buffer_load_dwordx4 v[180:183], v3, s[20:23], s35 offen offset:2048 sc1
    buffer_load_dwordx4 v[184:187], v3, s[20:23], s35 offen offset:3072 sc1
    buffer_load_dwordx2 v[188:189], v192, s[20:23], s36 offen sc1
    buffer_load_dwordx2 v[190:191], v192, s[20:23], s36 offen offset:256 sc1
    s_add_u32 s35, s35, 0x1000
    s_add_u32 s36, s36, 0x400
    v_mfma_f32_32x32x16_bf16 v[48:63], v[16:19], v[112:115], v[48:63]
    ds_read_b64_tr_b16 v[32:33], v8 offset:25600
    ds_read_b64_tr_b16 v[34:35], v8 offset:26624
    ds_read_b64_tr_b16 v[36:37], v9 offset:25600
    v_mfma_f32_32x32x16_bf16 v[64:79], v[20:23], v[112:115], v[64:79]
    ds_read_b64_tr_b16 v[38:39], v9 offset:26624
    ds_read_b64_tr_b16 v[40:41], v10 offset:25600
    ds_read_b64_tr_b16 v[42:43], v10 offset:26624
    v_mfma_f32_32x32x16_bf16 v[80:95], v[24:27], v[112:115], v[80:95]
    ds_read_b64_tr_b16 v[44:45], v11 offset:25600
    ds_read_b64_tr_b16 v[46:47], v11 offset:26624
    v_mfma_f32_32x32x16_bf16 v[96:111], v[28:31], v[112:115], v[96:111]
    s_waitcnt lgkmcnt(0)
    v_mfma_f32_32x32x16_bf16 v[48:63], v[32:35], v[116:119], v[48:63]
    ds_read_b64_tr_b16 v[16:17], v8 offset:30720
    ds_read_b64_tr_b16 v[18:19], v8 offset:31744
    ds_read_b64_tr_b16 v[20:21], v9 offset:30720
    v_mfma_f32_32x32x16_bf16 v[64:79], v[36:39], v[116:119], v[64:79]
    ds_read_b64_tr_b16 v[22:23], v9 offset:31744
    ds_read_b64_tr_b16 v[24:25], v10 offset:30720
    ds_read_b64_tr_b16 v[26:27], v10 offset:31744
    v_mfma_f32_32x32x16_bf16 v[80:95], v[40:43], v[116:119], v[80:95]
    ds_read_b64_tr_b16 v[28:29], v11 offset:30720
    ds_read_b64_tr_b16 v[30:31], v11 offset:31744
    v_mfma_f32_32x32x16_bf16 v[96:111], v[44:47], v[116:119], v[96:111]
    s_waitcnt lgkmcnt(0)
    v_mfma_f32_32x32x16_bf16 v[48:63], v[16:19], v[120:123], v[48:63]
    ds_read_b64_tr_b16 v[32:33], v8 offset:35840
    ds_read_b64_tr_b16 v[34:35], v8 offset:36864
    ds_read_b64_tr_b16 v[36:37], v9 offset:35840
    v_mfma_f32_32x32x16_bf16 v[64:79], v[20:23], v[120:123], v[64:79]
    ds_read_b64_tr_b16 v[38:39], v9 offset:36864
    ds_read_b64_tr_b16 v[40:41], v10 offset:35840
    ds_read_b64_tr_b16 v[42:43], v10 offset:36864
    v_mfma_f32_32x32x16_bf16 v[80:95], v[24:27], v[120:123], v[80:95]
    ds_read_b64_tr_b16 v[44:45], v11 offset:35840
    ds_read_b64_tr_b16 v[46:47], v11 offset:36864
    v_mfma_f32_32x32x16_bf16 v[96:111], v[28:31], v[120:123], v[96:111]
    s_waitcnt lgkmcnt(0)
    v_mfma_f32_32x32x16_bf16 v[48:63], v[32:35], v[124:127], v[48:63]
    ds_read_b64_tr_b16 v[16:17], v12 offset:24576
    ds_read_b64_tr_b16 v[18:19], v12 offset:29696
    ds_read_b64_tr_b16 v[20:21], v13 offset:24576
    v_mfma_f32_32x32x16_bf16 v[64:79], v[36:39], v[124:127], v[64:79]
    ds_read_b64_tr_b16 v[22:23], v13 offset:29696
    ds_read_b64_tr_b16 v[24:25], v14 offset:24576
    ds_read_b64_tr_b16 v[26:27], v14 offset:29696
    v_mfma_f32_32x32x16_bf16 v[80:95], v[40:43], v[124:127], v[80:95]
    ds_read_b64_tr_b16 v[28:29], v15 offset:24576
    ds_read_b64_tr_b16 v[30:31], v15 offset:29696
    v_mfma_f32_32x32x16_bf16 v[96:111], v[44:47], v[124:127], v[96:111]
    s_waitcnt lgkmcnt(0)
    v_mfma_f32_32x32x16_bf16 v[48:63], v[16:19], v[128:131], v[48:63]
    v_add_u32 v8, 4294844416, v8
    v_add_u32 v9, 4294844416, v9
    v_add_u32 v10, 4294844416, v10
    v_add_u32 v11, 4294844416, v11
    v_add_u32 v12, 4294844416, v12
    v_add_u32 v13, 4294844416, v13
    v_add_u32 v14, 4294844416, v14
    v_add_u32 v15, 4294844416, v15
    s_barrier
    s_barrier
    ds_read_b64_tr_b16 v[32:33], v8 offset:0
    ds_read_b64_tr_b16 v[34:35], v8 offset:1024
    ds_read_b64_tr_b16 v[36:37], v9 offset:0
    v_mfma_f32_32x32x16_bf16 v[64:79], v[20:23], v[128:131], v[64:79]
    ds_read_b64_tr_b16 v[38:39], v9 offset:1024
    ds_read_b64_tr_b16 v[40:41], v10 offset:0
    ds_read_b64_tr_b16 v[42:43], v10 offset:1024
    v_mfma_f32_32x32x16_bf16 v[80:95], v[24:27], v[128:131], v[80:95]
    ds_read_b64_tr_b16 v[44:45], v11 offset:0
    ds_read_b64_tr_b16 v[46:47], v11 offset:1024
    v_mfma_f32_32x32x16_bf16 v[96:111], v[28:31], v[128:131], v[96:111]
    s_waitcnt vmcnt(12) lgkmcnt(0)
    v_mfma_f32_32x32x16_bf16 v[48:63], v[32:35], v[132:135], v[48:63]
    ds_read_b64_tr_b16 v[16:17], v8 offset:5120
    ds_read_b64_tr_b16 v[18:19], v8 offset:6144
    ds_read_b64_tr_b16 v[20:21], v9 offset:5120
    v_mfma_f32_32x32x16_bf16 v[64:79], v[36:39], v[132:135], v[64:79]
    ds_read_b64_tr_b16 v[22:23], v9 offset:6144
    ds_read_b64_tr_b16 v[24:25], v10 offset:5120
    ds_read_b64_tr_b16 v[26:27], v10 offset:6144
    v_mfma_f32_32x32x16_bf16 v[80:95], v[40:43], v[132:135], v[80:95]
    ds_read_b64_tr_b16 v[28:29], v11 offset:5120
    ds_read_b64_tr_b16 v[30:31], v11 offset:6144
    v_mfma_f32_32x32x16_bf16 v[96:111], v[44:47], v[132:135], v[96:111]
    s_waitcnt lgkmcnt(0)
    v_mfma_f32_32x32x16_bf16 v[48:63], v[16:19], v[136:139], v[48:63]
    ds_read_b64_tr_b16 v[32:33], v8 offset:10240
    ds_read_b64_tr_b16 v[34:35], v8 offset:11264
    ds_read_b64_tr_b16 v[36:37], v9 offset:10240
    v_mfma_f32_32x32x16_bf16 v[64:79], v[20:23], v[136:139], v[64:79]
    ds_read_b64_tr_b16 v[38:39], v9 offset:11264
    ds_read_b64_tr_b16 v[40:41], v10 offset:10240
    ds_read_b64_tr_b16 v[42:43], v10 offset:11264
    v_mfma_f32_32x32x16_bf16 v[80:95], v[24:27], v[136:139], v[80:95]
    ds_read_b64_tr_b16 v[44:45], v11 offset:10240
    ds_read_b64_tr_b16 v[46:47], v11 offset:11264
    v_mfma_f32_32x32x16_bf16 v[96:111], v[28:31], v[136:139], v[96:111]
    s_waitcnt lgkmcnt(0)
    v_mfma_f32_32x32x16_bf16 v[48:63], v[32:35], v[140:143], v[48:63]
    ds_read_b64_tr_b16 v[16:17], v8 offset:15360
    ds_read_b64_tr_b16 v[18:19], v8 offset:16384
    ds_read_b64_tr_b16 v[20:21], v9 offset:15360
    v_mfma_f32_32x32x16_bf16 v[64:79], v[36:39], v[140:143], v[64:79]
    ds_read_b64_tr_b16 v[22:23], v9 offset:16384
    ds_read_b64_tr_b16 v[24:25], v10 offset:15360
    ds_read_b64_tr_b16 v[26:27], v10 offset:16384
    v_mfma_f32_32x32x16_bf16 v[80:95], v[40:43], v[140:143], v[80:95]
    ds_read_b64_tr_b16 v[28:29], v11 offset:15360
    ds_read_b64_tr_b16 v[30:31], v11 offset:16384
    v_mfma_f32_32x32x16_bf16 v[96:111], v[44:47], v[140:143], v[96:111]
    s_waitcnt lgkmcnt(0)
    v_mfma_f32_32x32x16_bf16 v[48:63], v[16:19], v[144:147], v[48:63]
    ds_read_b64_tr_b16 v[32:33], v12 offset:4096
    ds_read_b64_tr_b16 v[34:35], v12 offset:9216
    ds_read_b64_tr_b16 v[36:37], v13 offset:4096
    v_mfma_f32_32x32x16_bf16 v[64:79], v[20:23], v[144:147], v[64:79]
    ds_read_b64_tr_b16 v[38:39], v13 offset:9216
    ds_read_b64_tr_b16 v[40:41], v14 offset:4096
    ds_read_b64_tr_b16 v[42:43], v14 offset:9216
    v_mfma_f32_32x32x16_bf16 v[80:95], v[24:27], v[144:147], v[80:95]
    ds_read_b64_tr_b16 v[44:45], v15 offset:4096
    ds_read_b64_tr_b16 v[46:47], v15 offset:9216
    v_mfma_f32_32x32x16_bf16 v[96:111], v[28:31], v[144:147], v[96:111]
    s_waitcnt lgkmcnt(0)
    v_mfma_f32_32x32x16_bf16 v[48:63], v[32:35], v[148:151], v[48:63]
    ds_read_b64_tr_b16 v[16:17], v8 offset:20480
    ds_read_b64_tr_b16 v[18:19], v8 offset:21504
    ds_read_b64_tr_b16 v[20:21], v9 offset:20480
    v_mfma_f32_32x32x16_bf16 v[64:79], v[36:39], v[148:151], v[64:79]
    ds_read_b64_tr_b16 v[22:23], v9 offset:21504
    ds_read_b64_tr_b16 v[24:25], v10 offset:20480
    ds_read_b64_tr_b16 v[26:27], v10 offset:21504
    v_mfma_f32_32x32x16_bf16 v[80:95], v[40:43], v[148:151], v[80:95]
    ds_read_b64_tr_b16 v[28:29], v11 offset:20480
    ds_read_b64_tr_b16 v[30:31], v11 offset:21504
    v_mfma_f32_32x32x16_bf16 v[96:111], v[44:47], v[148:151], v[96:111]
    s_waitcnt vmcnt(6) lgkmcnt(0)
    v_mfma_f32_32x32x16_bf16 v[48:63], v[16:19], v[152:155], v[48:63]
    ds_read_b64_tr_b16 v[32:33], v8 offset:25600
    ds_read_b64_tr_b16 v[34:35], v8 offset:26624
    ds_read_b64_tr_b16 v[36:37], v9 offset:25600
    v_mfma_f32_32x32x16_bf16 v[64:79], v[20:23], v[152:155], v[64:79]
    ds_read_b64_tr_b16 v[38:39], v9 offset:26624
    ds_read_b64_tr_b16 v[40:41], v10 offset:25600
    ds_read_b64_tr_b16 v[42:43], v10 offset:26624
    v_mfma_f32_32x32x16_bf16 v[80:95], v[24:27], v[152:155], v[80:95]
    ds_read_b64_tr_b16 v[44:45], v11 offset:25600
    ds_read_b64_tr_b16 v[46:47], v11 offset:26624
    v_mfma_f32_32x32x16_bf16 v[96:111], v[28:31], v[152:155], v[96:111]
    s_waitcnt lgkmcnt(0)
    v_mfma_f32_32x32x16_bf16 v[48:63], v[32:35], v[156:159], v[48:63]
    ds_read_b64_tr_b16 v[16:17], v8 offset:30720
    ds_read_b64_tr_b16 v[18:19], v8 offset:31744
    ds_read_b64_tr_b16 v[20:21], v9 offset:30720
    v_mfma_f32_32x32x16_bf16 v[64:79], v[36:39], v[156:159], v[64:79]
    ds_read_b64_tr_b16 v[22:23], v9 offset:31744
    ds_read_b64_tr_b16 v[24:25], v10 offset:30720
    ds_read_b64_tr_b16 v[26:27], v10 offset:31744
    v_mfma_f32_32x32x16_bf16 v[80:95], v[40:43], v[156:159], v[80:95]
    ds_read_b64_tr_b16 v[28:29], v11 offset:30720
    ds_read_b64_tr_b16 v[30:31], v11 offset:31744
    v_mfma_f32_32x32x16_bf16 v[96:111], v[44:47], v[156:159], v[96:111]
    s_waitcnt lgkmcnt(0)
    v_mfma_f32_32x32x16_bf16 v[48:63], v[16:19], v[160:163], v[48:63]
    ds_read_b64_tr_b16 v[32:33], v8 offset:35840
    ds_read_b64_tr_b16 v[34:35], v8 offset:36864
    ds_read_b64_tr_b16 v[36:37], v9 offset:35840
    v_mfma_f32_32x32x16_bf16 v[64:79], v[20:23], v[160:163], v[64:79]
    ds_read_b64_tr_b16 v[38:39], v9 offset:36864
    ds_read_b64_tr_b16 v[40:41], v10 offset:35840
    ds_read_b64_tr_b16 v[42:43], v10 offset:36864
    v_mfma_f32_32x32x16_bf16 v[80:95], v[24:27], v[160:163], v[80:95]
    ds_read_b64_tr_b16 v[44:45], v11 offset:35840
    ds_read_b64_tr_b16 v[46:47], v11 offset:36864
    v_mfma_f32_32x32x16_bf16 v[96:111], v[28:31], v[160:163], v[96:111]
    s_waitcnt lgkmcnt(0)
    v_mfma_f32_32x32x16_bf16 v[48:63], v[32:35], v[164:167], v[48:63]
    ds_read_b64_tr_b16 v[16:17], v12 offset:24576
    ds_read_b64_tr_b16 v[18:19], v12 offset:29696
    ds_read_b64_tr_b16 v[20:21], v13 offset:24576
    v_mfma_f32_32x32x16_bf16 v[64:79], v[36:39], v[164:167], v[64:79]
    ds_read_b64_tr_b16 v[22:23], v13 offset:29696
    ds_read_b64_tr_b16 v[24:25], v14 offset:24576
    ds_read_b64_tr_b16 v[26:27], v14 offset:29696
    v_mfma_f32_32x32x16_bf16 v[80:95], v[40:43], v[164:167], v[80:95]
    ds_read_b64_tr_b16 v[28:29], v15 offset:24576
    ds_read_b64_tr_b16 v[30:31], v15 offset:29696
    v_mfma_f32_32x32x16_bf16 v[96:111], v[44:47], v[164:167], v[96:111]
    s_waitcnt lgkmcnt(0)
    v_mfma_f32_32x32x16_bf16 v[48:63], v[16:19], v[168:171], v[48:63]
    ds_read_b64_tr_b16 v[32:33], v8 offset:40960
    ds_read_b64_tr_b16 v[34:35], v8 offset:41984
    ds_read_b64_tr_b16 v[36:37], v9 offset:40960
    v_mfma_f32_32x32x16_bf16 v[64:79], v[20:23], v[168:171], v[64:79]
    ds_read_b64_tr_b16 v[38:39], v9 offset:41984
    ds_read_b64_tr_b16 v[40:41], v10 offset:40960
    ds_read_b64_tr_b16 v[42:43], v10 offset:41984
    v_mfma_f32_32x32x16_bf16 v[80:95], v[24:27], v[168:171], v[80:95]
    ds_read_b64_tr_b16 v[44:45], v11 offset:40960
    ds_read_b64_tr_b16 v[46:47], v11 offset:41984
    v_mfma_f32_32x32x16_bf16 v[96:111], v[28:31], v[168:171], v[96:111]
    s_waitcnt vmcnt(0) lgkmcnt(0)
    v_mfma_f32_32x32x16_bf16 v[48:63], v[32:35], v[172:175], v[48:63]
    ds_read_b64_tr_b16 v[16:17], v8 offset:46080
    ds_read_b64_tr_b16 v[18:19], v8 offset:47104
    ds_read_b64_tr_b16 v[20:21], v9 offset:46080
    v_mfma_f32_32x32x16_bf16 v[64:79], v[36:39], v[172:175], v[64:79]
    ds_read_b64_tr_b16 v[22:23], v9 offset:47104
    ds_read_b64_tr_b16 v[24:25], v10 offset:46080
    ds_read_b64_tr_b16 v[26:27], v10 offset:47104
    v_mfma_f32_32x32x16_bf16 v[80:95], v[40:43], v[172:175], v[80:95]
    ds_read_b64_tr_b16 v[28:29], v11 offset:46080
    ds_read_b64_tr_b16 v[30:31], v11 offset:47104
    v_mfma_f32_32x32x16_bf16 v[96:111], v[44:47], v[172:175], v[96:111]
    s_waitcnt lgkmcnt(0)
    v_mfma_f32_32x32x16_bf16 v[48:63], v[16:19], v[176:179], v[48:63]
    ds_read_b64_tr_b16 v[32:33], v8 offset:51200
    ds_read_b64_tr_b16 v[34:35], v8 offset:52224
    ds_read_b64_tr_b16 v[36:37], v9 offset:51200
    v_mfma_f32_32x32x16_bf16 v[64:79], v[20:23], v[176:179], v[64:79]
    ds_read_b64_tr_b16 v[38:39], v9 offset:52224
    ds_read_b64_tr_b16 v[40:41], v10 offset:51200
    ds_read_b64_tr_b16 v[42:43], v10 offset:52224
    v_mfma_f32_32x32x16_bf16 v[80:95], v[24:27], v[176:179], v[80:95]
    ds_read_b64_tr_b16 v[44:45], v11 offset:51200
    ds_read_b64_tr_b16 v[46:47], v11 offset:52224
    v_mfma_f32_32x32x16_bf16 v[96:111], v[28:31], v[176:179], v[96:111]
    s_waitcnt lgkmcnt(0)
    v_mfma_f32_32x32x16_bf16 v[48:63], v[32:35], v[180:183], v[48:63]
    ds_read_b64_tr_b16 v[16:17], v8 offset:56320
    ds_read_b64_tr_b16 v[18:19], v8 offset:57344
    ds_read_b64_tr_b16 v[20:21], v9 offset:56320
    v_mfma_f32_32x32x16_bf16 v[64:79], v[36:39], v[180:183], v[64:79]
    ds_read_b64_tr_b16 v[22:23], v9 offset:57344
    ds_read_b64_tr_b16 v[24:25], v10 offset:56320
    ds_read_b64_tr_b16 v[26:27], v10 offset:57344
    v_mfma_f32_32x32x16_bf16 v[80:95], v[40:43], v[180:183], v[80:95]
    ds_read_b64_tr_b16 v[28:29], v11 offset:56320
    ds_read_b64_tr_b16 v[30:31], v11 offset:57344
    v_mfma_f32_32x32x16_bf16 v[96:111], v[44:47], v[180:183], v[96:111]
    s_waitcnt lgkmcnt(0)
    v_mfma_f32_32x32x16_bf16 v[48:63], v[16:19], v[184:187], v[48:63]
    ds_read_b64_tr_b16 v[32:33], v12 offset:45056
    ds_read_b64_tr_b16 v[34:35], v12 offset:50176
    ds_read_b64_tr_b16 v[36:37], v13 offset:45056
    v_mfma_f32_32x32x16_bf16 v[64:79], v[20:23], v[184:187], v[64:79]
    ds_read_b64_tr_b16 v[38:39], v13 offset:50176
    ds_read_b64_tr_b16 v[40:41], v14 offset:45056
    ds_read_b64_tr_b16 v[42:43], v14 offset:50176
    v_mfma_f32_32x32x16_bf16 v[80:95], v[24:27], v[184:187], v[80:95]
    ds_read_b64_tr_b16 v[44:45], v15 offset:45056
    ds_read_b64_tr_b16 v[46:47], v15 offset:50176
    v_mfma_f32_32x32x16_bf16 v[96:111], v[28:31], v[184:187], v[96:111]
    s_waitcnt lgkmcnt(0)
    v_mfma_f32_32x32x16_bf16 v[48:63], v[32:35], v[188:191], v[48:63]
    v_mfma_f32_32x32x16_bf16 v[64:79], v[36:39], v[188:191], v[64:79]
    v_mfma_f32_32x32x16_bf16 v[80:95], v[40:43], v[188:191], v[80:95]
    v_mfma_f32_32x32x16_bf16 v[96:111], v[44:47], v[188:191], v[96:111]
    s_nop 8
    v_cvt_pk_bf16_f32 v16, v48, v49
    v_cvt_pk_bf16_f32 v17, v50, v51
    v_cvt_pk_bf16_f32 v18, v52, v53
    v_cvt_pk_bf16_f32 v19, v54, v55
    s_nop 0
    v_permlane32_swap_b32 v16, v18
    v_permlane32_swap_b32 v17, v19
    buffer_store_dwordx4 v[16:19], v4, s[24:27], 0 offen offset:0
    v_cvt_pk_bf16_f32 v20, v56, v57
    v_cvt_pk_bf16_f32 v21, v58, v59
    v_cvt_pk_bf16_f32 v22, v60, v61
    v_cvt_pk_bf16_f32 v23, v62, v63
    s_nop 0
    v_permlane32_swap_b32 v20, v22
    v_permlane32_swap_b32 v21, v23
    buffer_store_dwordx4 v[20:23], v4, s[24:27], 0 offen offset:32
    v_cvt_pk_bf16_f32 v24, v64, v65
    v_cvt_pk_bf16_f32 v25, v66, v67
    v_cvt_pk_bf16_f32 v26, v68, v69
    v_cvt_pk_bf16_f32 v27, v70, v71
    s_nop 0
    v_permlane32_swap_b32 v24, v26
    v_permlane32_swap_b32 v25, v27
    buffer_store_dwordx4 v[24:27], v4, s[24:27], 0 offen offset:64
    v_cvt_pk_bf16_f32 v28, v72, v73
    v_cvt_pk_bf16_f32 v29, v74, v75
    v_cvt_pk_bf16_f32 v30, v76, v77
    v_cvt_pk_bf16_f32 v31, v78, v79
    s_nop 0
    v_permlane32_swap_b32 v28, v30
    v_permlane32_swap_b32 v29, v31
    buffer_store_dwordx4 v[28:31], v4, s[24:27], 0 offen offset:96
    v_cvt_pk_bf16_f32 v32, v80, v81
    v_cvt_pk_bf16_f32 v33, v82, v83
    v_cvt_pk_bf16_f32 v34, v84, v85
    v_cvt_pk_bf16_f32 v35, v86, v87
    s_nop 0
    v_permlane32_swap_b32 v32, v34
    v_permlane32_swap_b32 v33, v35
    buffer_store_dwordx4 v[32:35], v4, s[24:27], 0 offen offset:128
    v_cvt_pk_bf16_f32 v36, v88, v89
    v_cvt_pk_bf16_f32 v37, v90, v91
    v_cvt_pk_bf16_f32 v38, v92, v93
    v_cvt_pk_bf16_f32 v39, v94, v95
    s_nop 0
    v_permlane32_swap_b32 v36, v38
    v_permlane32_swap_b32 v37, v39
    buffer_store_dwordx4 v[36:39], v4, s[24:27], 0 offen offset:160
    v_cvt_pk_bf16_f32 v40, v96, v97
    v_cvt_pk_bf16_f32 v41, v98, v99
    v_cvt_pk_bf16_f32 v42, v100, v101
    v_cvt_pk_bf16_f32 v43, v102, v103
    s_nop 0
    v_permlane32_swap_b32 v40, v42
    v_permlane32_swap_b32 v41, v43
    buffer_store_dwordx4 v[40:43], v4, s[24:27], 0 offen offset:192
    v_cvt_pk_bf16_f32 v44, v104, v105
    v_cvt_pk_bf16_f32 v45, v106, v107
    v_cvt_pk_bf16_f32 v46, v108, v109
    v_cvt_pk_bf16_f32 v47, v110, v111
    s_nop 0
    v_permlane32_swap_b32 v44, v46
    v_permlane32_swap_b32 v45, v47
    buffer_store_dwordx4 v[44:47], v4, s[24:27], 0 offen offset:224
    s_endpgm
K3_A:
    v_add_u32 v8, 61440, v8
    v_add_u32 v9, 61440, v9
    v_add_u32 v10, 61440, v10
    v_add_u32 v11, 61440, v11
    v_add_u32 v12, 61440, v12
    v_add_u32 v13, 61440, v13
    v_add_u32 v14, 61440, v14
    v_add_u32 v15, 61440, v15
    v_lshlrev_b32 v5, 2, v1
    v_add_u32 v5, s39, v5
    s_waitcnt vmcnt(0)
    s_barrier
    s_mov_b32 s89, 0
K3_Q2:
    buffer_load_dword v6, v5, s[96:99], 0 offen sc1
    s_add_u32 s89, s89, 1
    s_waitcnt vmcnt(0)
    v_xor_b32 v6, s91, v6
    v_cmp_ne_u32 vcc, 0, v6
    s_cbranch_vccz K3_Q2X
    s_sleep 2
    s_cmp_lt_u32 s89, 0x8000
    s_cbranch_scc1 K3_Q2
K3_Q2X:
    buffer_load_dwordx4 v[112:115], v3, s[20:23], s35 offen offset:0 sc1
    buffer_load_dwordx4 v[116:119], v3, s[20:23], s35 offen offset:1024 sc1
    buffer_load_dwordx4 v[120:123], v3, s[20:23], s35 offen offset:2048 sc1
    buffer_load_dwordx4 v[124:127], v3, s[20:23], s35 offen offset:3072 sc1
    buffer_load_dwordx2 v[128:129], v192, s[20:23], s36 offen sc1
    buffer_load_dwordx2 v[130:131], v192, s[20:23], s36 offen offset:256 sc1
    s_add_u32 s35, s35, 0x1000
    s_add_u32 s36, s36, 0x400
    buffer_load_dwordx4 v[132:135], v3, s[20:23], s35 offen offset:0 sc1
    buffer_load_dwordx4 v[136:139], v3, s[20:23], s35 offen offset:1024 sc1
    buffer_load_dwordx4 v[140:143], v3, s[20:23], s35 offen offset:2048 sc1
    buffer_load_dwordx4 v[144:147], v3, s[20:23], s35 offen offset:3072 sc1
    buffer_load_dwordx2 v[148:149], v192, s[20:23], s36 offen sc1
    buffer_load_dwordx2 v[150:151], v192, s[20:23], s36 offen offset:256 sc1
    s_add_u32 s35, s35, 0x1000
    s_add_u32 s36, s36, 0x400
    buffer_load_dwordx4 v[152:155], v3, s[20:23], s35 offen offset:0 sc1
    buffer_load_dwordx4 v[156:159], v3, s[20:23], s35 offen offset:1024 sc1
    buffer_load_dwordx4 v[160:163], v3, s[20:23], s35 offen offset:2048 sc1
    buffer_load_dwordx4 v[164:167], v3, s[20:23], s35 offen offset:3072 sc1
    buffer_load_dwordx2 v[168:169], v192, s[20:23], s36 offen sc1
    buffer_load_dwordx2 v[170:171], v192, s[20:23], s36 offen offset:256 sc1
    s_add_u32 s35, s35, 0x1000
    s_add_u32 s36, s36, 0x400
    buffer_load_dwordx4 v[172:175], v3, s[20:23], s35 offen offset:0 sc1
    buffer_load_dwordx4 v[176:179], v3, s[20:23], s35 offen offset:1024 sc1
    buffer_load_dwordx4 v[180:183], v3, s[20:23], s35 offen offset:2048 sc1
    buffer_load_dwordx4 v[184:187], v3, s[20:23], s35 offen offset:3072 sc1
    buffer_load_dwordx2 v[188:189], v192, s[20:23], s36 offen sc1
    buffer_load_dwordx2 v[190:191], v192, s[20:23], s36 offen offset:256 sc1
    s_add_u32 s35, s35, 0x1000
    s_add_u32 s36, s36, 0x400
    ds_read_b64_tr_b16 v[16:17], v8 offset:0
    ds_read_b64_tr_b16 v[18:19], v8 offset:1024
    ds_read_b64_tr_b16 v[20:21], v9 offset:0
    ds_read_b64_tr_b16 v[22:23], v9 offset:1024
    s_waitcnt vmcnt(18) lgkmcnt(0)
    v_mfma_f32_32x32x16_bf16 v[48:63], v[16:19], v[112:115], v[48:63]
    ds_read_b64_tr_b16 v[32:33], v8 offset:5120
    ds_read_b64_tr_b16 v[34:35], v8 offset:6144
    ds_read_b64_tr_b16 v[36:37], v9 offset:5120
    ds_read_b64_tr_b16 v[38:39], v9 offset:6144
    v_mfma_f32_32x32x16_bf16 v[64:79], v[20:23], v[112:115], v[64:79]
    s_waitcnt lgkmcnt(0)
    v_mfma_f32_32x32x16_bf16 v[48:63], v[32:35], v[116:119], v[48:63]
    ds_read_b64_tr_b16 v[16:17], v8 offset:10240
    ds_read_b64_tr_b16 v[18:19], v8 offset:11264
    ds_read_b64_tr_b16 v[20:21], v9 offset:10240
    ds_read_b64_tr_b16 v[22:23], v9 offset:11264
    v_mfma_f32_32x32x16_bf16 v[64:79], v[36:39], v[116:119], v[64:79]
    s_waitcnt lgkmcnt(0)
    v_mfma_f32_32x32x16_bf16 v[48:63], v[16:19], v[120:123], v[48:63]
    ds_read_b64_tr_b16 v[32:33], v8 offset:15360
    ds_read_b64_tr_b16 v[34:35], v8 offset:16384
    ds_read_b64_tr_b16 v[36:37], v9 offset:15360
    ds_read_b64_tr_b16 v[38:39], v9 offset:16384
    v_mfma_f32_32x32x16_bf16 v[64:79], v[20:23], v[120:123], v[64:79]
    s_waitcnt lgkmcnt(0)
    v_mfma_f32_32x32x16_bf16 v[48:63], v[32:35], v[124:127], v[48:63]
    ds_read_b64_tr_b16 v[16:17], v12 offset:4096
    ds_read_b64_tr_b16 v[18:19], v12 offset:9216
    ds_read_b64_tr_b16 v[20:21], v13 offset:4096
    ds_read_b64_tr_b16 v[22:23], v13 offset:9216
    v_mfma_f32_32x32x16_bf16 v[64:79], v[36:39], v[124:127], v[64:79]
    s_waitcnt lgkmcnt(0)
    v_mfma_f32_32x32x16_bf16 v[48:63], v[16:19], v[128:131], v[48:63]
    ds_read_b64_tr_b16 v[32:33], v8 offset:20480
    ds_read_b64_tr_b16 v[34:35], v8 offset:21504
    ds_read_b64_tr_b16 v[36:37], v9 offset:20480
    ds_read_b64_tr_b16 v[38:39], v9 offset:21504
    v_mfma_f32_32x32x16_bf16 v[64:79], v[20:23], v[128:131], v[64:79]
    s_waitcnt vmcnt(12) lgkmcnt(0)
    buffer_load_dwordx4 v[112:115], v3, s[20:23], s35 offen offset:0 sc1
    buffer_load_dwordx4 v[116:119], v3, s[20:23], s35 offen offset:1024 sc1
    buffer_load_dwordx4 v[120:123], v3, s[20:23], s35 offen offset:2048 sc1
    buffer_load_dwordx4 v[124:127], v3, s[20:23], s35 offen offset:3072 sc1
    buffer_load_dwordx2 v[128:129], v192, s[20:23], s36 offen sc1
    buffer_load_dwordx2 v[130:131], v192, s[20:23], s36 offen offset:256 sc1
    s_add_u32 s35, s35, 0x1000
    s_add_u32 s36, s36, 0x400
    v_mfma_f32_32x32x16_bf16 v[48:63], v[32:35], v[132:135], v[48:63]
    ds_read_b64_tr_b16 v[16:17], v8 offset:25600
    ds_read_b64_tr_b16 v[18:19], v8 offset:26624
    ds_read_b64_tr_b16 v[20:21], v9 offset:25600
    ds_read_b64_tr_b16 v[22:23], v9 offset:26624
    v_mfma_f32_32x32x16_bf16 v[64:79], v[36:39], v[132:135], v[64:79]
    s_waitcnt lgkmcnt(0)
    v_mfma_f32_32x32x16_bf16 v[48:63], v[16:19], v[136:139], v[48:63]
    ds_read_b64_tr_b16 v[32:33], v8 offset:30720
    ds_read_b64_tr_b16 v[34:35], v8 offset:31744
    ds_read_b64_tr_b16 v[36:37], v9 offset:30720
    ds_read_b64_tr_b16 v[38:39], v9 offset:31744
    v_mfma_f32_32x32x16_bf16 v[64:79], v[20:23], v[136:139], v[64:79]
    s_waitcnt lgkmcnt(0)
    v_mfma_f32_32x32x16_bf16 v[48:63], v[32:35], v[140:143], v[48:63]
    ds_read_b64_tr_b16 v[16:17], v8 offset:35840
    ds_read_b64_tr_b16 v[18:19], v8 offset:36864
    ds_read_b64_tr_b16 v[20:21], v9 offset:35840
    ds_read_b64_tr_b16 v[22:23], v9 offset:36864
    v_mfma_f32_32x32x16_bf16 v[64:79], v[36:39], v[140:143], v[64:79]
    s_waitcnt lgkmcnt(0)
    v_mfma_f32_32x32x16_bf16 v[48:63], v[16:19], v[144:147], v[48:63]
    ds_read_b64_tr_b16 v[32:33], v12 offset:24576
    ds_read_b64_tr_b16 v[34:35], v12 offset:29696
    ds_read_b64_tr_b16 v[36:37], v13 offset:24576
    ds_read_b64_tr_b16 v[38:39], v13 offset:29696
    v_mfma_f32_32x32x16_bf16 v[64:79], v[20:23], v[144:147], v[64:79]
    s_waitcnt lgkmcnt(0)
    v_mfma_f32_32x32x16_bf16 v[48:63], v[32:35], v[148:151], v[48:63]
    ds_read_b64_tr_b16 v[16:17], v8 offset:40960
    ds_read_b64_tr_b16 v[18:19], v8 offset:41984
    ds_read_b64_tr_b16 v[20:21], v9 offset:40960
    ds_read_b64_tr_b16 v[22:23], v9 offset:41984
    v_mfma_f32_32x32x16_bf16 v[64:79], v[36:39], v[148:151], v[64:79]
    s_waitcnt vmcnt(12) lgkmcnt(0)
    buffer_load_dwordx4 v[132:135], v3, s[20:23], s35 offen offset:0 sc1
    buffer_load_dwordx4 v[136:139], v3, s[20:23], s35 offen offset:1024 sc1
    buffer_load_dwordx4 v[140:143], v3, s[20:23], s35 offen offset:2048 sc1
    buffer_load_dwordx4 v[144:147], v3, s[20:23], s35 offen offset:3072 sc1
    buffer_load_dwordx2 v[148:149], v192, s[20:23], s36 offen sc1
    buffer_load_dwordx2 v[150:151], v192, s[20:23], s36 offen offset:256 sc1
    s_add_u32 s35, s35, 0x1000
    s_add_u32 s36, s36, 0x400
    v_mfma_f32_32x32x16_bf16 v[48:63], v[16:19], v[152:155], v[48:63]
    ds_read_b64_tr_b16 v[32:33], v8 offset:46080
    ds_read_b64_tr_b16 v[34:35], v8 offset:47104
    ds_read_b64_tr_b16 v[36:37], v9 offset:46080
    ds_read_b64_tr_b16 v[38:39], v9 offset:47104
    v_mfma_f32_32x32x16_bf16 v[64:79], v[20:23], v[152:155], v[64:79]
    s_waitcnt lgkmcnt(0)
    v_mfma_f32_32x32x16_bf16 v[48:63], v[32:35], v[156:159], v[48:63]
    ds_read_b64_tr_b16 v[16:17], v8 offset:51200
    ds_read_b64_tr_b16 v[18:19], v8 offset:52224
    ds_read_b64_tr_b16 v[20:21], v9 offset:51200
    ds_read_b64_tr_b16 v[22:23], v9 offset:52224
    v_mfma_f32_32x32x16_bf16 v[64:79], v[36:39], v[156:159], v[64:79]
    s_waitcnt lgkmcnt(0)
    v_mfma_f32_32x32x16_bf16 v[48:63], v[16:19], v[160:163], v[48:63]
    ds_read_b64_tr_b16 v[32:33], v8 offset:56320
    ds_read_b64_tr_b16 v[34:35], v8 offset:57344
    ds_read_b64_tr_b16 v[36:37], v9 offset:56320
    ds_read_b64_tr_b16 v[38:39], v9 offset:57344
    v_mfma_f32_32x32x16_bf16 v[64:79], v[20:23], v[160:163], v[64:79]
    s_waitcnt lgkmcnt(0)
    v_mfma_f32_32x32x16_bf16 v[48:63], v[32:35], v[164:167], v[48:63]
    ds_read_b64_tr_b16 v[16:17], v12 offset:45056
    ds_read_b64_tr_b16 v[18:19], v12 offset:50176
    ds_read_b64_tr_b16 v[20:21], v13 offset:45056
    ds_read_b64_tr_b16 v[22:23], v13 offset:50176
    v_mfma_f32_32x32x16_bf16 v[64:79], v[36:39], v[164:167], v[64:79]
    s_waitcnt lgkmcnt(0)
    v_mfma_f32_32x32x16_bf16 v[48:63], v[16:19], v[168:171], v[48:63]
    v_add_u32 v8, 61440, v8
    v_add_u32 v9, 61440, v9
    v_add_u32 v10, 61440, v10
    v_add_u32 v11, 61440, v11
    v_add_u32 v12, 61440, v12
    v_add_u32 v13, 61440, v13
    v_add_u32 v14, 61440, v14
    v_add_u32 v15, 61440, v15
    ds_read_b64_tr_b16 v[32:33], v8 offset:0
    ds_read_b64_tr_b16 v[34:35], v8 offset:1024
    ds_read_b64_tr_b16 v[36:37], v9 offset:0
    ds_read_b64_tr_b16 v[38:39], v9 offset:1024
    v_mfma_f32_32x32x16_bf16 v[64:79], v[20:23], v[168:171], v[64:79]
    s_waitcnt vmcnt(12) lgkmcnt(0)
    buffer_load_dwordx4 v[152:155], v3, s[20:23], s35 offen offset:0 sc1
    buffer_load_dwordx4 v[156:159], v3, s[20:23], s35 offen offset:1024 sc1
    buffer_load_dwordx4 v[160:163], v3, s[20:23], s35 offen offset:2048 sc1
    buffer_load_dwordx4 v[164:167], v3, s[20:23], s35 offen offset:3072 sc1
    buffer_load_dwordx2 v[168:169], v192, s[20:23], s36 offen sc1
    buffer_load_dwordx2 v[170:171], v192, s[20:23], s36 offen offset:256 sc1
    s_add_u32 s35, s35, 0x1000
    s_add_u32 s36, s36, 0x400
    v_mfma_f32_32x32x16_bf16 v[48:63], v[32:35], v[172:175], v[48:63]
    ds_read_b64_tr_b16 v[16:17], v8 offset:5120
    ds_read_b64_tr_b16 v[18:19], v8 offset:6144
    ds_read_b64_tr_b16 v[20:21], v9 offset:5120
    ds_read_b64_tr_b16 v[22:23], v9 offset:6144
    v_mfma_f32_32x32x16_bf16 v[64:79], v[36:39], v[172:175], v[64:79]
    s_waitcnt lgkmcnt(0)
    v_mfma_f32_32x32x16_bf16 v[48:63], v[16:19], v[176:179], v[48:63]
    ds_read_b64_tr_b16 v[32:33], v8 offset:10240
    ds_read_b64_tr_b16 v[34:35], v8 offset:11264
    ds_read_b64_tr_b16 v[36:37], v9 offset:10240
    ds_read_b64_tr_b16 v[38:39], v9 offset:11264
    v_mfma_f32_32x32x16_bf16 v[64:79], v[20:23], v[176:179], v[64:79]
    s_waitcnt lgkmcnt(0)
    v_mfma_f32_32x32x16_bf16 v[48:63], v[32:35], v[180:183], v[48:63]
    ds_read_b64_tr_b16 v[16:17], v8 offset:15360
    ds_read_b64_tr_b16 v[18:19], v8 offset:16384
    ds_read_b64_tr_b16 v[20:21], v9 offset:15360
    ds_read_b64_tr_b16 v[22:23], v9 offset:16384
    v_mfma_f32_32x32x16_bf16 v[64:79], v[36:39], v[180:183], v[64:79]
    s_waitcnt lgkmcnt(0)
    v_mfma_f32_32x32x16_bf16 v[48:63], v[16:19], v[184:187], v[48:63]
    ds_read_b64_tr_b16 v[32:33], v12 offset:4096
    ds_read_b64_tr_b16 v[34:35], v12 offset:9216
    ds_read_b64_tr_b16 v[36:37], v13 offset:4096
    ds_read_b64_tr_b16 v[38:39], v13 offset:9216
    v_mfma_f32_32x32x16_bf16 v[64:79], v[20:23], v[184:187], v[64:79]
    s_waitcnt lgkmcnt(0)
    v_mfma_f32_32x32x16_bf16 v[48:63], v[32:35], v[188:191], v[48:63]
    ds_read_b64_tr_b16 v[16:17], v8 offset:20480
    ds_read_b64_tr_b16 v[18:19], v8 offset:21504
    ds_read_b64_tr_b16 v[20:21], v9 offset:20480
    ds_read_b64_tr_b16 v[22:23], v9 offset:21504
    v_mfma_f32_32x32x16_bf16 v[64:79], v[36:39], v[188:191], v[64:79]
    s_waitcnt vmcnt(12) lgkmcnt(0)
    buffer_load_dwordx4 v[172:175], v3, s[20:23], s35 offen offset:0 sc1
    buffer_load_dwordx4 v[176:179], v3, s[20:23], s35 offen offset:1024 sc1
    buffer_load_dwordx4 v[180:183], v3, s[20:23], s35 offen offset:2048 sc1
    buffer_load_dwordx4 v[184:187], v3, s[20:23], s35 offen offset:3072 sc1
    buffer_load_dwordx2 v[188:189], v192, s[20:23], s36 offen sc1
    buffer_load_dwordx2 v[190:191], v192, s[20:23], s36 offen offset:256 sc1
    s_add_u32 s35, s35, 0x1000
    s_add_u32 s36, s36, 0x400
    v_mfma_f32_32x32x16_bf16 v[48:63], v[16:19], v[112:115], v[48:63]
    ds_read_b64_tr_b16 v[32:33], v8 offset:25600
    ds_read_b64_tr_b16 v[34:35], v8 offset:26624
    ds_read_b64_tr_b16 v[36:37], v9 offset:25600
    ds_read_b64_tr_b16 v[38:39], v9 offset:26624
    v_mfma_f32_32x32x16_bf16 v[64:79], v[20:23], v[112:115], v[64:79]
    s_waitcnt lgkmcnt(0)
    v_mfma_f32_32x32x16_bf16 v[48:63], v[32:35], v[116:119], v[48:63]
    ds_read_b64_tr_b16 v[16:17], v8 offset:30720
    ds_read_b64_tr_b16 v[18:19], v8 offset:31744
    ds_read_b64_tr_b16 v[20:21], v9 offset:30720
    ds_read_b64_tr_b16 v[22:23], v9 offset:31744
    v_mfma_f32_32x32x16_bf16 v[64:79], v[36:39], v[116:119], v[64:79]
    s_waitcnt lgkmcnt(0)
    v_mfma_f32_32x32x16_bf16 v[48:63], v[16:19], v[120:123], v[48:63]
    ds_read_b64_tr_b16 v[32:33], v8 offset:35840
    ds_read_b64_tr_b16 v[34:35], v8 offset:36864
    ds_read_b64_tr_b16 v[36:37], v9 offset:35840
    ds_read_b64_tr_b16 v[38:39], v9 offset:36864
    v_mfma_f32_32x32x16_bf16 v[64:79], v[20:23], v[120:123], v[64:79]
    s_waitcnt lgkmcnt(0)
    v_mfma_f32_32x32x16_bf16 v[48:63], v[32:35], v[124:127], v[48:63]
    ds_read_b64_tr_b16 v[16:17], v12 offset:24576
    ds_read_b64_tr_b16 v[18:19], v12 offset:29696
    ds_read_b64_tr_b16 v[20:21], v13 offset:24576
    ds_read_b64_tr_b16 v[22:23], v13 offset:29696
    v_mfma_f32_32x32x16_bf16 v[64:79], v[36:39], v[124:127], v[64:79]
    s_waitcnt lgkmcnt(0)
    v_mfma_f32_32x32x16_bf16 v[48:63], v[16:19], v[128:131], v[48:63]
    v_add_u32 v8, 4294844416, v8
    v_add_u32 v9, 4294844416, v9
    v_add_u32 v10, 4294844416, v10
    v_add_u32 v11, 4294844416, v11
    v_add_u32 v12, 4294844416, v12
    v_add_u32 v13, 4294844416, v13
    v_add_u32 v14, 4294844416, v14
    v_add_u32 v15, 4294844416, v15
    s_barrier
    ds_read_b64_tr_b16 v[32:33], v8 offset:0
    ds_read_b64_tr_b16 v[34:35], v8 offset:1024
    ds_read_b64_tr_b16 v[36:37], v9 offset:0
    ds_read_b64_tr_b16 v[38:39], v9 offset:1024
    v_mfma_f32_32x32x16_bf16 v[64:79], v[20:23], v[128:131], v[64:79]
    s_waitcnt vmcnt(12) lgkmcnt(0)
    v_mfma_f32_32x32x16_bf16 v[48:63], v[32:35], v[132:135], v[48:63]
    ds_read_b64_tr_b16 v[16:17], v8 offset:5120
    ds_read_b64_tr_b16 v[18:19], v8 offset:6144
    ds_read_b64_tr_b16 v[20:21], v9 offset:5120
    ds_read_b64_tr_b16 v[22:23], v9 offset:6144
    v_mfma_f32_32x32x16_bf16 v[64:79], v[36:39], v[132:135], v[64:79]
    s_waitcnt lgkmcnt(0)
    v_mfma_f32_32x32x16_bf16 v[48:63], v[16:19], v[136:139], v[48:63]
    ds_read_b64_tr_b16 v[32:33], v8 offset:10240
    ds_read_b64_tr_b16 v[34:35], v8 offset:11264
    ds_read_b64_tr_b16 v[36:37], v9 offset:10240
    ds_read_b64_tr_b16 v[38:39], v9 offset:11264
    v_mfma_f32_32x32x16_bf16 v[64:79], v[20:23], v[136:139], v[64:79]
    s_waitcnt lgkmcnt(0)
    v_mfma_f32_32x32x16_bf16 v[48:63], v[32:35], v[140:143], v[48:63]
    ds_read_b64_tr_b16 v[16:17], v8 offset:15360
    ds_read_b64_tr_b16 v[18:19], v8 offset:16384
    ds_read_b64_tr_b16 v[20:21], v9 offset:15360
    ds_read_b64_tr_b16 v[22:23], v9 offset:16384
    v_mfma_f32_32x32x16_bf16 v[64:79], v[36:39], v[140:143], v[64:79]
    s_waitcnt lgkmcnt(0)
    v_mfma_f32_32x32x16_bf16 v[48:63], v[16:19], v[144:147], v[48:63]
    ds_read_b64_tr_b16 v[32:33], v12 offset:4096
    ds_read_b64_tr_b16 v[34:35], v12 offset:9216
    ds_read_b64_tr_b16 v[36:37], v13 offset:4096
    ds_read_b64_tr_b16 v[38:39], v13 offset:9216
    v_mfma_f32_32x32x16_bf16 v[64:79], v[20:23], v[144:147], v[64:79]
    s_waitcnt lgkmcnt(0)
    v_mfma_f32_32x32x16_bf16 v[48:63], v[32:35], v[148:151], v[48:63]
    ds_read_b64_tr_b16 v[16:17], v8 offset:20480
    ds_read_b64_tr_b16 v[18:19], v8 offset:21504
    ds_read_b64_tr_b16 v[20:21], v9 offset:20480
    ds_read_b64_tr_b16 v[22:23], v9 offset:21504
    v_mfma_f32_32x32x16_bf16 v[64:79], v[36:39], v[148:151], v[64:79]
    s_waitcnt vmcnt(6) lgkmcnt(0)
    v_mfma_f32_32x32x16_bf16 v[48:63], v[16:19], v[152:155], v[48:63]
    ds_read_b64_tr_b16 v[32:33], v8 offset:25600
    ds_read_b64_tr_b16 v[34:35], v8 offset:26624
    ds_read_b64_tr_b16 v[36:37], v9 offset:25600
    ds_read_b64_tr_b16 v[38:39], v9 offset:26624
    v_mfma_f32_32x32x16_bf16 v[64:79], v[20:23], v[152:155], v[64:79]
    s_waitcnt lgkmcnt(0)
    v_mfma_f32_32x32x16_bf16 v[48:63], v[32:35], v[156:159], v[48:63]
    ds_read_b64_tr_b16 v[16:17], v8 offset:30720
    ds_read_b64_tr_b16 v[18:19], v8 offset:31744
    ds_read_b64_tr_b16 v[20:21], v9 offset:30720
    ds_read_b64_tr_b16 v[22:23], v9 offset:31744
    v_mfma_f32_32x32x16_bf16 v[64:79], v[36:39], v[156:159], v[64:79]
    s_waitcnt lgkmcnt(0)
    v_mfma_f32_32x32x16_bf16 v[48:63], v[16:19], v[160:163], v[48:63]
    ds_read_b64_tr_b16 v[32:33], v8 offset:35840
    ds_read_b64_tr_b16 v[34:35], v8 offset:36864
    ds_read_b64_tr_b16 v[36:37], v9 offset:35840
    ds_read_b64_tr_b16 v[38:39], v9 offset:36864
    v_mfma_f32_32x32x16_bf16 v[64:79], v[20:23], v[160:163], v[64:79]
    s_waitcnt lgkmcnt(0)
    v_mfma_f32_32x32x16_bf16 v[48:63], v[32:35], v[164:167], v[48:63]
    ds_read_b64_tr_b16 v[16:17], v12 offset:24576
    ds_read_b64_tr_b16 v[18:19], v12 offset:29696
    ds_read_b64_tr_b16 v[20:21], v13 offset:24576
    ds_read_b64_tr_b16 v[22:23], v13 offset:29696
    v_mfma_f32_32x32x16_bf16 v[64:79], v[36:39], v[164:167], v[64:79]
    s_waitcnt lgkmcnt(0)
    v_mfma_f32_32x32x16_bf16 v[48:63], v[16:19], v[168:171], v[48:63]
    ds_read_b64_tr_b16 v[32:33], v8 offset:40960
    ds_read_b64_tr_b16 v[34:35], v8 offset:41984
    ds_read_b64_tr_b16 v[36:37], v9 offset:40960
    ds_read_b64_tr_b16 v[38:39], v9 offset:41984
    v_mfma_f32_32x32x16_bf16 v[64:79], v[20:23], v[168:171], v[64:79]
    s_waitcnt vmcnt(0) lgkmcnt(0)
    v_mfma_f32_32x32x16_bf16 v[48:63], v[32:35], v[172:175], v[48:63]
    ds_read_b64_tr_b16 v[16:17], v8 offset:46080
    ds_read_b64_tr_b16 v[18:19], v8 offset:47104
    ds_read_b64_tr_b16 v[20:21], v9 offset:46080
    ds_read_b64_tr_b16 v[22:23], v9 offset:47104
    v_mfma_f32_32x32x16_bf16 v[64:79], v[36:39], v[172:175], v[64:79]
    s_waitcnt lgkmcnt(0)
    v_mfma_f32_32x32x16_bf16 v[48:63], v[16:19], v[176:179], v[48:63]
    ds_read_b64_tr_b16 v[32:33], v8 offset:51200
    ds_read_b64_tr_b16 v[34:35], v8 offset:52224
    ds_read_b64_tr_b16 v[36:37], v9 offset:51200
    ds_read_b64_tr_b16 v[38:39], v9 offset:52224
    v_mfma_f32_32x32x16_bf16 v[64:79], v[20:23], v[176:179], v[64:79]
    s_waitcnt lgkmcnt(0)
    v_mfma_f32_32x32x16_bf16 v[48:63], v[32:35], v[180:183], v[48:63]
    ds_read_b64_tr_b16 v[16:17], v8 offset:56320
    ds_read_b64_tr_b16 v[18:19], v8 offset:57344
    ds_read_b64_tr_b16 v[20:21], v9 offset:56320
    ds_read_b64_tr_b16 v[22:23], v9 offset:57344
    v_mfma_f32_32x32x16_bf16 v[64:79], v[36:39], v[180:183], v[64:79]
    s_waitcnt lgkmcnt(0)
    v_mfma_f32_32x32x16_bf16 v[48:63], v[16:19], v[184:187], v[48:63]
    ds_read_b64_tr_b16 v[32:33], v12 offset:45056
    ds_read_b64_tr_b16 v[34:35], v12 offset:50176
    ds_read_b64_tr_b16 v[36:37], v13 offset:45056
    ds_read_b64_tr_b16 v[38:39], v13 offset:50176
    v_mfma_f32_32x32x16_bf16 v[64:79], v[20:23], v[184:187], v[64:79]
    s_waitcnt lgkmcnt(0)
    v_mfma_f32_32x32x16_bf16 v[48:63], v[32:35], v[188:191], v[48:63]
    v_mfma_f32_32x32x16_bf16 v[64:79], v[36:39], v[188:191], v[64:79]
    s_nop 10
    v_cvt_pk_bf16_f32 v16, v48, v49
    v_cvt_pk_bf16_f32 v17, v50, v51
    v_cvt_pk_bf16_f32 v18, v52, v53
    v_cvt_pk_bf16_f32 v19, v54, v55
    s_nop 0
    v_permlane32_swap_b32 v16, v18
    v_permlane32_swap_b32 v17, v19
    buffer_store_dwordx4 v[16:19], v4, s[24:27], 0 offen offset:0
    v_cvt_pk_bf16_f32 v20, v56, v57
    v_cvt_pk_bf16_f32 v21, v58, v59
    v_cvt_pk_bf16_f32 v22, v60, v61
    v_cvt_pk_bf16_f32 v23, v62, v63
    s_nop 0
    v_permlane32_swap_b32 v20, v22
    v_permlane32_swap_b32 v21, v23
    buffer_store_dwordx4 v[20:23], v4, s[24:27], 0 offen offset:32
    v_cvt_pk_bf16_f32 v24, v64, v65
    v_cvt_pk_bf16_f32 v25, v66, v67
    v_cvt_pk_bf16_f32 v26, v68, v69
    v_cvt_pk_bf16_f32 v27, v70, v71
    s_nop 0
    v_permlane32_swap_b32 v24, v26
    v_permlane32_swap_b32 v25, v27
    buffer_store_dwordx4 v[24:27], v4, s[24:27], 0 offen offset:64
    v_cvt_pk_bf16_f32 v28, v72, v73
    v_cvt_pk_bf16_f32 v29, v74, v75
    v_cvt_pk_bf16_f32 v30, v76, v77
    v_cvt_pk_bf16_f32 v31, v78, v79
    s_nop 0
    v_permlane32_swap_b32 v28, v30
    v_permlane32_swap_b32 v29, v31
    buffer_store_dwordx4 v[28:31], v4, s[24:27], 0 offen offset:96
K3_END:
    s_endpgm
ALL_END:
.section .rodata,"a"
.p2align 6
.amdhsa_kernel concat_heads__mha_block__linear_kernel_hedgehog__prompt_kernel
  .amdhsa_next_free_vgpr 252
  .amdhsa_next_free_sgpr 96
  .amdhsa_accum_offset 252
  .amdhsa_group_segment_fixed_size 0
  .amdhsa_kernarg_size 80
  .amdhsa_user_sgpr_count 2
  .amdhsa_user_sgpr_kernarg_segment_ptr 1
  .amdhsa_system_sgpr_workgroup_id_x 1
.end_amdhsa_kernel
```
